```python
import torch

def _softmax(x, axis=-1):
    return torch.softmax(x, dim=axis)
def _gelu(x):
    return torch.nn.functional.gelu(x, approximate="tanh")
def _silu(x):
    return torch.nn.functional.silu(x)
def _sigmoid(x):
    return torch.sigmoid(x)
def _layernorm(x, axis=-1, eps=1e-5):
    m = x.mean(dim=axis, keepdim=True)
    v = x.var(dim=axis, keepdim=True, unbiased=False)
    return (x - m) / torch.sqrt(v + eps)
def _scatter_add(tgt, idx, src, axis=0):
    return tgt.clone().index_add_(axis, idx, src)
def _segment_sum(src, seg, n):
    out = torch.zeros((n,) + src.shape[1:], dtype=src.dtype)
    return out.index_add_(0, seg, src)
def _pad(x, pw):
    flat = tuple(v for pair in reversed(pw) for v in pair)
    return torch.nn.functional.pad(x, flat)

kernel_name = 'standalone__edge_featured_mpnn_egc__graph'

def setup_inputs():

    _w = (lambda a: (lambda t: t.to(torch.bfloat16) if t.is_floating_point() else t)(torch.as_tensor(a)))
    N, deg, D, De = 10000, 16, 256, max(16, 1)
    E = N * deg
    return {
        "x": _w((lambda *s: torch.randn(*s, dtype=torch.bfloat16) * 0.1)(N, D)),
        "e_attr": _w((lambda *s: torch.randn(*s, dtype=torch.bfloat16) * 0.1)(E, De)),
        "src": _w((lambda lo, hi, *s: torch.randint(lo, hi, s))(0, N, E).to(torch.int64)),
        "dst": _w((lambda lo, hi, *s: torch.randint(lo, hi, s))(0, N, E).to(torch.int64)),
        "u_w": _w((lambda *s: torch.randn(*s, dtype=torch.bfloat16) * 0.05)(D, D)),
        "v_w": _w((lambda *s: torch.randn(*s, dtype=torch.bfloat16) * 0.05)(D, D)),
        "g_w": _w((lambda *s: torch.randn(*s, dtype=torch.bfloat16) * 0.1)(2 * D + De, D)),
    }

def reference(x, e_attr, src, dst, u_w, v_w, g_w):
    N, D = x.shape
    g_in = torch.concatenate([x[dst], x[src], e_attr], axis=-1)
    eta = _sigmoid(g_in @ g_w)
    hv = x @ v_w
    msg = eta * hv[src]
    agg = _segment_sum(msg, dst, N)
    return _silu(x @ u_w + agg)
```

```asm
; @launch kernel=egc_k1_kernel grid=(257,1,1) block=(512,1,1) lds=163840
; @launch kernel=egc_k2_kernel grid=(256,1,1) block=(512,1,1) lds=157696
.amdgcn_target "amdgcn-amd-amdhsa--gfx950"
.text
.globl egc_k1_kernel
.p2align 8
.type egc_k1_kernel,@function
egc_k1_kernel:
    s_cmp_ge_u32 s2, 257
    s_cbranch_scc1 L_k1_exit
    s_cmp_lt_u32 s2, 192
    s_cbranch_scc1 L_k1_gemm
    s_cmp_eq_u32 s2, 256
    s_cbranch_scc1 L_k1_misc
    s_sub_u32 s40, s2, 192
    s_load_dwordx4 s[4:7], s[0:1], 8
    s_load_dwordx2 s[8:9], s[0:1], 24
    s_load_dwordx2 s[10:11], s[0:1], 72
    v_lshlrev_b32 v1, 2, v0
    v_lshlrev_b32 v2, 4, v0
    v_mov_b32 v3, 0
    v_add_u32 v71, 95488, v1
    ds_write_b32 v71, v3
    s_mul_i32 s28, s40, 10000
    s_mul_i32 s29, s40, 80000
    s_waitcnt lgkmcnt(0)
    s_mov_b32 s12, s4
    s_and_b32 s13, s5, 0xffff
    s_mov_b32 s14, 0x4e2000
    s_mov_b32 s15, 0x00020000
    s_mov_b32 s16, s6
    s_and_b32 s17, s7, 0xffff
    s_mov_b32 s18, 0x9c400
    s_mov_b32 s19, 0x00020000
    s_mov_b32 s20, s8
    s_and_b32 s21, s9, 0xffff
    s_mov_b32 s22, 0x9c400
    s_mov_b32 s23, 0x00020000
    s_mov_b32 s24, s10
    s_and_b32 s25, s11, 0xffff
    s_mov_b32 s26, 0x4000000
    s_mov_b32 s27, 0x00020000
    s_add_u32 s30, s28, 0
    buffer_load_dword v4, v1, s[20:23], s30 offen
    s_add_u32 s30, s28, 2048
    buffer_load_dword v5, v1, s[20:23], s30 offen
    s_add_u32 s30, s28, 4096
    buffer_load_dword v6, v1, s[20:23], s30 offen
    s_add_u32 s30, s28, 6144
    buffer_load_dword v7, v1, s[20:23], s30 offen
    s_add_u32 s30, s28, 8192
    buffer_load_dword v8, v1, s[20:23], s30 offen
    s_add_u32 s30, s28, 0
    buffer_load_dword v9, v1, s[16:19], s30 offen
    s_add_u32 s30, s28, 2048
    buffer_load_dword v10, v1, s[16:19], s30 offen
    s_add_u32 s30, s28, 4096
    buffer_load_dword v11, v1, s[16:19], s30 offen
    s_add_u32 s30, s28, 6144
    buffer_load_dword v12, v1, s[16:19], s30 offen
    s_add_u32 s30, s28, 8192
    buffer_load_dword v13, v1, s[16:19], s30 offen
    s_barrier
    s_movk_i32 s31, 625
    s_waitcnt vmcnt(0)
    v_mul_u32_u24 v56, 214749, v4
    v_lshrrev_b32 v56, 22, v56
    v_mad_u32_u24 v72, v56, s31, 31
    v_lshrrev_b32 v72, 5, v72
    v_sub_u32 v72, v4, v72
    v_mul_u32_u24 v72, 0xd00000, v72
    v_lshlrev_b32 v73, 28, v56
    v_add3_u32 v66, v9, v72, v73
    v_lshlrev_b32 v56, 2, v56
    v_mul_u32_u24 v57, 214749, v5
    v_lshrrev_b32 v57, 22, v57
    v_mad_u32_u24 v72, v57, s31, 31
    v_lshrrev_b32 v72, 5, v72
    v_sub_u32 v72, v5, v72
    v_mul_u32_u24 v72, 0xd00000, v72
    v_lshlrev_b32 v73, 28, v57
    v_add3_u32 v67, v10, v72, v73
    v_lshlrev_b32 v57, 2, v57
    v_mul_u32_u24 v58, 214749, v6
    v_lshrrev_b32 v58, 22, v58
    v_mad_u32_u24 v72, v58, s31, 31
    v_lshrrev_b32 v72, 5, v72
    v_sub_u32 v72, v6, v72
    v_mul_u32_u24 v72, 0xd00000, v72
    v_lshlrev_b32 v73, 28, v58
    v_add3_u32 v68, v11, v72, v73
    v_lshlrev_b32 v58, 2, v58
    v_mul_u32_u24 v59, 214749, v7
    v_lshrrev_b32 v59, 22, v59
    v_mad_u32_u24 v72, v59, s31, 31
    v_lshrrev_b32 v72, 5, v72
    v_sub_u32 v72, v7, v72
    v_mul_u32_u24 v72, 0xd00000, v72
    v_lshlrev_b32 v73, 28, v59
    v_add3_u32 v69, v12, v72, v73
    v_lshlrev_b32 v59, 2, v59
    v_mul_u32_u24 v60, 214749, v8
    v_lshrrev_b32 v60, 22, v60
    v_mad_u32_u24 v72, v60, s31, 31
    v_lshrrev_b32 v72, 5, v72
    v_sub_u32 v72, v8, v72
    v_mul_u32_u24 v72, 0xd00000, v72
    v_lshlrev_b32 v73, 28, v60
    v_add3_u32 v70, v13, v72, v73
    v_lshlrev_b32 v60, 2, v60
    v_mov_b32 v3, 1
    v_add_u32 v56, 95488, v56
    ds_add_rtn_u32 v61, v56, v3
    v_add_u32 v57, 95488, v57
    ds_add_rtn_u32 v62, v57, v3
    v_add_u32 v58, 95488, v58
    ds_add_rtn_u32 v63, v58, v3
    v_add_u32 v59, 95488, v59
    ds_add_rtn_u32 v64, v59, v3
    v_add_u32 v60, 95488, v60
    v_cmp_gt_u32 vcc, 452, v0
    s_and_saveexec_b64 s[32:33], vcc
    ds_add_rtn_u32 v65, v60, v3
    s_mov_b64 exec, s[32:33]
    s_waitcnt lgkmcnt(0)
    s_barrier
    s_add_u32 s30, s29, 0
    buffer_load_dwordx4 v[16:19], v2, s[12:15], s30 offen
    s_add_u32 s30, s29, 8192
    buffer_load_dwordx4 v[20:23], v2, s[12:15], s30 offen
    s_add_u32 s30, s29, 16384
    buffer_load_dwordx4 v[24:27], v2, s[12:15], s30 offen
    s_add_u32 s30, s29, 24576
    buffer_load_dwordx4 v[28:31], v2, s[12:15], s30 offen
    s_add_u32 s30, s29, 32768
    buffer_load_dwordx4 v[32:35], v2, s[12:15], s30 offen
    s_add_u32 s30, s29, 40960
    buffer_load_dwordx4 v[36:39], v2, s[12:15], s30 offen
    s_add_u32 s30, s29, 49152
    buffer_load_dwordx4 v[40:43], v2, s[12:15], s30 offen
    s_add_u32 s30, s29, 57344
    buffer_load_dwordx4 v[44:47], v2, s[12:15], s30 offen
    s_add_u32 s30, s29, 65536
    buffer_load_dwordx4 v[48:51], v2, s[12:15], s30 offen
    s_add_u32 s30, s29, 73728
    buffer_load_dwordx4 v[52:55], v2, s[12:15], s30 offen
    ds_read_b32 v74, v71
    s_waitcnt lgkmcnt(0)
    v_mov_b32 v75, v74
    s_nop 1
    v_add_u32_dpp v75, v75, v75 row_shr:1 row_mask:0xf bank_mask:0xf bound_ctrl:0
    s_nop 1
    v_add_u32_dpp v75, v75, v75 row_shr:2 row_mask:0xf bank_mask:0xf bound_ctrl:0
    s_nop 1
    v_add_u32_dpp v75, v75, v75 row_shr:4 row_mask:0xf bank_mask:0xf bound_ctrl:0
    s_nop 1
    v_add_u32_dpp v75, v75, v75 row_shr:8 row_mask:0xf bank_mask:0xf bound_ctrl:0
    s_nop 1
    v_add_u32_dpp v75, v75, v75 row_bcast:15 row_mask:0xa bank_mask:0xf
    s_nop 1
    v_add_u32_dpp v75, v75, v75 row_bcast:31 row_mask:0xc bank_mask:0xf
    s_nop 1
    v_lshrrev_b32 v76, 6, v0
    v_lshlrev_b32 v77, 2, v76
    v_add_u32 v77, 99584, v77
    v_and_b32 v78, 63, v0
    v_cmp_eq_u32 vcc, 63, v78
    s_and_saveexec_b64 s[32:33], vcc
    ds_write_b32 v77, v75
    s_mov_b64 exec, s[32:33]
    v_readfirstlane_b32 s34, v76
    s_waitcnt lgkmcnt(0)
    s_barrier
    v_lshlrev_b32 v77, 2, v78
    v_add_u32 v77, 99584, v77
    ds_read_b32 v79, v77
    s_waitcnt lgkmcnt(0)
    v_cmp_gt_u32 vcc, s34, v78
    s_nop 1
    v_cndmask_b32 v79, 0, v79, vcc
    s_nop 1
    v_add_u32_dpp v79, v79, v79 row_shr:1 row_mask:0xf bank_mask:0xf bound_ctrl:0
    s_nop 1
    v_add_u32_dpp v79, v79, v79 row_shr:2 row_mask:0xf bank_mask:0xf bound_ctrl:0
    s_nop 1
    v_add_u32_dpp v79, v79, v79 row_shr:4 row_mask:0xf bank_mask:0xf bound_ctrl:0
    s_nop 1
    v_add_u32_dpp v79, v79, v79 row_shr:8 row_mask:0xf bank_mask:0xf bound_ctrl:0
    s_nop 1
    v_add_u32_dpp v79, v79, v79 row_bcast:15 row_mask:0xa bank_mask:0xf
    s_nop 1
    v_add_u32_dpp v79, v79, v79 row_bcast:31 row_mask:0xc bank_mask:0xf
    s_nop 1
    v_readlane_b32 s35, v79, 63
    s_nop 1
    v_add_u32 v75, s35, v75
    v_sub_u32 v74, v75, v74
    v_add_u32 v77, 2048, v71
    ds_write_b32 v77, v74
    v_lshlrev_b32 v76, 1, v0
    s_mul_i32 s30, s40, 1088
    s_add_u32 s30, s30, 26869760
    buffer_store_short v74, v76, s[24:27], s30 offen
    v_cmp_eq_u32 vcc, 511, v0
    s_and_saveexec_b64 s[32:33], vcc
    s_cbranch_execz L_sort_nolast
    buffer_store_short v75, v76, s[24:27], s30 offen offset:2
    L_sort_nolast:
    s_mov_b64 exec, s[32:33]
    s_waitcnt lgkmcnt(0)
    s_barrier
    ds_read_b32 v80, v56 offset:2048
    ds_read_b32 v81, v57 offset:2048
    ds_read_b32 v82, v58 offset:2048
    ds_read_b32 v83, v59 offset:2048
    ds_read_b32 v84, v60 offset:2048
    s_waitcnt lgkmcnt(0)
    v_add_u32 v61, v61, v80
    v_add_u32 v62, v62, v81
    v_add_u32 v63, v63, v82
    v_add_u32 v64, v64, v83
    v_add_u32 v65, v65, v84
    v_add_u32 v76, 90368, v76
    v_lshlrev_b32 v72, 2, v61
    v_add_u32 v72, 80128, v72
    ds_write_b32 v72, v66
    ds_write_b16 v76, v61 offset:0
    v_lshlrev_b32 v72, 2, v62
    v_add_u32 v72, 80128, v72
    ds_write_b32 v72, v67
    ds_write_b16 v76, v62 offset:1024
    v_lshlrev_b32 v72, 2, v63
    v_add_u32 v72, 80128, v72
    ds_write_b32 v72, v68
    ds_write_b16 v76, v63 offset:2048
    v_lshlrev_b32 v72, 2, v64
    v_add_u32 v72, 80128, v72
    ds_write_b32 v72, v69
    ds_write_b16 v76, v64 offset:3072
    v_cmp_gt_u32 vcc, 452, v0
    s_and_saveexec_b64 s[32:33], vcc
    v_lshlrev_b32 v72, 2, v65
    v_add_u32 v72, 80128, v72
    ds_write_b32 v72, v70
    ds_write_b16 v76, v65 offset:4096
    s_mov_b64 exec, s[32:33]
    s_waitcnt lgkmcnt(0)
    s_barrier
    v_lshrrev_b32 v76, 1, v0
    v_lshlrev_b32 v76, 1, v76
    v_add_u32 v76, 90368, v76
    v_and_b32 v77, 1, v0
    v_lshlrev_b32 v77, 4, v77
    ds_read_u16 v56, v76 offset:0
    ds_read_u16 v57, v76 offset:512
    ds_read_u16 v58, v76 offset:1024
    ds_read_u16 v59, v76 offset:1536
    ds_read_u16 v60, v76 offset:2048
    ds_read_u16 v61, v76 offset:2560
    ds_read_u16 v62, v76 offset:3072
    ds_read_u16 v63, v76 offset:3584
    ds_read_u16 v64, v76 offset:4096
    ds_read_u16 v65, v76 offset:4608
    s_waitcnt vmcnt(0) lgkmcnt(0)
    v_lshl_add_u32 v56, v56, 5, v77
    ds_write_b128 v56, v[16:19]
    v_lshl_add_u32 v57, v57, 5, v77
    ds_write_b128 v57, v[20:23]
    v_lshl_add_u32 v58, v58, 5, v77
    ds_write_b128 v58, v[24:27]
    v_lshl_add_u32 v59, v59, 5, v77
    ds_write_b128 v59, v[28:31]
    v_lshl_add_u32 v60, v60, 5, v77
    ds_write_b128 v60, v[32:35]
    v_lshl_add_u32 v61, v61, 5, v77
    ds_write_b128 v61, v[36:39]
    v_lshl_add_u32 v62, v62, 5, v77
    ds_write_b128 v62, v[40:43]
    v_lshl_add_u32 v63, v63, 5, v77
    ds_write_b128 v63, v[44:47]
    v_lshl_add_u32 v64, v64, 5, v77
    ds_write_b128 v64, v[48:51]
    v_lshl_add_u32 v65, v65, 5, v77
    v_cmp_gt_u32 vcc, 392, v0
    s_and_saveexec_b64 s[32:33], vcc
    s_cbranch_execz L_sort_skip9
    ds_write_b128 v65, v[52:55]
    L_sort_skip9:
    s_mov_b64 exec, s[32:33]
    s_waitcnt lgkmcnt(0)
    s_barrier
    s_getpc_b64 s[36:37]
    L_k1_pc:
    s_add_u32 s36, s36, egc_k2_kernel-L_k1_pc
    s_addc_u32 s37, s37, 0
    v_lshlrev_b32 v74, 7, v0
    v_cmp_gt_u32 vcc, 102, v0
    s_and_saveexec_b64 s[38:39], vcc
    s_cbranch_execz L_k1_nopf
    global_load_dword v75, v74, s[36:37]
    L_k1_nopf:
    s_mov_b64 exec, s[38:39]
    ds_read_b128 v[16:19], v2 offset:0
    ds_read_b128 v[20:23], v2 offset:8192
    ds_read_b128 v[24:27], v2 offset:16384
    ds_read_b128 v[28:31], v2 offset:24576
    ds_read_b128 v[32:35], v2 offset:32768
    ds_read_b128 v[36:39], v2 offset:40960
    ds_read_b128 v[40:43], v2 offset:49152
    ds_read_b128 v[44:47], v2 offset:57344
    v_add_u32 v72, 65536, v2
    ds_read_b128 v[48:51], v72
    v_add_u32 v72, 73728, v2
    ds_read_b128 v[52:55], v72
    v_add_u32 v72, 80128, v2
    ds_read_b128 v[56:59], v72
    ds_read_b128 v[60:63], v72 offset:8192
    s_add_u32 s29, s29, 20971520
    s_add_u32 s28, s28, 26214400
    s_waitcnt lgkmcnt(0)
    s_add_u32 s30, s29, 0
    buffer_store_dwordx4 v[16:19], v2, s[24:27], s30 offen sc1
    s_add_u32 s30, s29, 8192
    buffer_store_dwordx4 v[20:23], v2, s[24:27], s30 offen sc1
    s_add_u32 s30, s29, 16384
    buffer_store_dwordx4 v[24:27], v2, s[24:27], s30 offen sc1
    s_add_u32 s30, s29, 24576
    buffer_store_dwordx4 v[28:31], v2, s[24:27], s30 offen sc1
    s_add_u32 s30, s29, 32768
    buffer_store_dwordx4 v[32:35], v2, s[24:27], s30 offen sc1
    s_add_u32 s30, s29, 40960
    buffer_store_dwordx4 v[36:39], v2, s[24:27], s30 offen sc1
    s_add_u32 s30, s29, 49152
    buffer_store_dwordx4 v[40:43], v2, s[24:27], s30 offen sc1
    s_add_u32 s30, s29, 57344
    buffer_store_dwordx4 v[44:47], v2, s[24:27], s30 offen sc1
    s_add_u32 s30, s29, 65536
    buffer_store_dwordx4 v[48:51], v2, s[24:27], s30 offen sc1
    buffer_store_dwordx4 v[56:59], v2, s[24:27], s28 offen sc1
    v_cmp_gt_u32 vcc, 392, v0
    s_and_saveexec_b64 s[32:33], vcc
    s_cbranch_execz L_sort_done
    s_add_u32 s30, s29, 73728
    buffer_store_dwordx4 v[52:55], v2, s[24:27], s30 offen sc1
    v_cmp_gt_u32 vcc, 113, v0
    s_and_b64 exec, exec, vcc
    s_cbranch_execz L_sort_done
    s_add_u32 s30, s28, 8192
    buffer_store_dwordx4 v[60:63], v2, s[24:27], s30 offen sc1
    L_sort_done:
    s_mov_b64 exec, -1
    s_endpgm
L_k1_gemm:
    s_load_dwordx2 s[4:5], s[0:1], 0
    s_load_dwordx4 s[8:11], s[0:1], 32
    s_load_dwordx2 s[6:7], s[0:1], 48
    s_load_dwordx2 s[28:29], s[0:1], 72
    s_load_dwordx2 s[60:61], s[0:1], 56
    s_sub_u32 s30, s2, 0
    s_lshr_b32 s32, s30, 3
    s_and_b32 s31, s32, 3
    s_lshr_b32 s52, s32, 2
    s_and_b32 s30, s30, 7
    s_lshl3_add_u32 s32, s52, s30
    s_cmp_ge_u32 s32, 45
    s_cbranch_scc1 L_gemm_spare
    v_and_b32 v1, 63, v0
    v_lshrrev_b32 v2, 6, v0
    s_nop 0
    v_readfirstlane_b32 s33, v2
    s_lshr_b32 s36, s31, 1
    s_and_b32 s37, s31, 1
    v_lshrrev_b32 v3, 4, v1
    v_bfe_u32 v4, v1, 2, 2
    v_xor_b32 v4, v4, v3
    v_lshlrev_b32 v4, 6, v4
    v_lshl_add_u32 v4, v3, 9, v4
    v_and_b32 v5, 3, v1
    v_lshl_add_u32 v2, v5, 4, v4
    s_and_b32 s34, s33, 3
    s_lshr_b32 s35, s33, 2
    s_lshl_b32 s39, s33, 11
    s_lshl_b32 s41, s33, 10
    v_lshrrev_b32 v3, 5, v1
    v_and_b32 v8, 31, v1
    v_xor_b32 v8, v8, v3
    s_and_b32 s43, s34, 1
    s_lshl_b32 s43, s43, 3
    v_xor_b32 v8, s43, v8
    v_lshlrev_b32 v8, 4, v8
    v_lshl_add_u32 v4, v3, 9, v8
    v_xor_b32 v5, 32, v4
    v_xor_b32 v6, 64, v4
    v_xor_b32 v7, 96, v4
    s_mul_i32 s44, s32, 7
    s_add_u32 s44, s44, s35
    s_lshl_b32 s46, s34, 12
    s_lshl_b32 s47, s35, 14
    s_lshl_b32 s55, s35, 16
    s_lshl_b32 s40, s37, 8
    s_cmp_eq_u32 s36, 0
    s_cselect_b32 s45, s40, 0
    s_cselect_b32 s38, 0x20000, 0
    s_add_u32 s42, s39, s45
    s_add_u32 s42, s42, s38
    s_cselect_b32 s45, s40, 0
    s_cmp_eq_u32 s36, 0
    s_cselect_b32 s45, s40, 0x100
    s_add_u32 s39, s39, s45
    s_waitcnt lgkmcnt(0)
    s_cmp_eq_u32 s31, 3
    s_cselect_b32 s56, s8, s6
    s_cselect_b32 s57, s9, s7
    s_cmp_eq_u32 s36, 0
    s_cselect_b32 s58, s10, s56
    s_cselect_b32 s59, s11, s57
    s_mov_b32 s20, s4
    s_and_b32 s21, s5, 0xffff
    s_mov_b32 s22, 0x4e2000
    s_mov_b32 s23, 0x00020000
    s_add_u32 s45, s44, 0
    s_lshl_b32 s45, s45, 14
    s_add_u32 s45, s45, s46
    s_add_u32 s48, s46, s47
    s_add_u32 m0, s48, 98304
    s_add_u32 s43, s45, 0
    buffer_load_dwordx4 v4, s[20:23], s43 offen lds
    s_add_u32 m0, s48, 99328
    s_add_u32 s43, s45, 1024
    buffer_load_dwordx4 v5, s[20:23], s43 offen lds
    s_add_u32 m0, s48, 100352
    s_add_u32 s43, s45, 2048
    buffer_load_dwordx4 v6, s[20:23], s43 offen lds
    s_add_u32 m0, s48, 101376
    s_add_u32 s43, s45, 3072
    buffer_load_dwordx4 v7, s[20:23], s43 offen lds
    s_mov_b32 s12, s56
    s_and_b32 s13, s57, 0xffff
    s_mov_b32 s14, 0x42000
    s_mov_b32 s15, 0x00020000
    s_mov_b32 s16, s58
    s_and_b32 s17, s59, 0xffff
    s_mov_b32 s18, 0x42000
    s_mov_b32 s19, 0x00020000
    s_add_u32 m0, s41, 0
    s_add_u32 s43, s42, 0
    buffer_load_dwordx4 v2, s[12:15], s43 offen lds
    s_add_u32 m0, s41, 16384
    s_add_u32 s43, s39, 0
    buffer_load_dwordx4 v2, s[16:19], s43 offen lds
    s_add_u32 m0, s41, 8192
    s_add_u32 s43, s42, 16384
    buffer_load_dwordx4 v2, s[12:15], s43 offen lds
    s_add_u32 m0, s41, 24576
    s_add_u32 s43, s39, 16384
    buffer_load_dwordx4 v2, s[16:19], s43 offen lds
    s_barrier
    s_add_u32 m0, s41, 32768
    s_add_u32 s43, s42, 32768
    buffer_load_dwordx4 v2, s[12:15], s43 offen lds
    s_add_u32 m0, s41, 49152
    s_add_u32 s43, s39, 32768
    buffer_load_dwordx4 v2, s[16:19], s43 offen lds
    s_add_u32 m0, s41, 40960
    s_add_u32 s43, s42, 49152
    buffer_load_dwordx4 v2, s[12:15], s43 offen lds
    s_add_u32 m0, s41, 57344
    s_add_u32 s43, s39, 49152
    buffer_load_dwordx4 v2, s[16:19], s43 offen lds
    s_lshl3_add_u32 s43, s52, s33
    s_mul_i32 s43, s43, 6
    v_add_u32 v48, s43, v1
    v_min_u32 v48, 255, v48
    v_lshrrev_b32 v49, 1, v48
    v_and_b32 v48, 1, v48
    v_lshlrev_b32 v48, 7, v48
    v_lshl_add_u32 v48, v49, 9, v48
    s_lshl_b32 s45, s33, 11
    s_sub_u32 s43, s42, s45
    s_add_u32 s43, s43, 0x10000
    s_sub_u32 s45, s39, s45
    s_add_u32 s45, s45, 0x10000
    s_mov_b32 exec_lo, 63
    s_mov_b32 exec_hi, 0
    buffer_load_dword v49, v48, s[12:15], s43 offen
    buffer_load_dword v49, v48, s[16:19], s45 offen
    s_mov_b64 exec, -1
    s_add_u32 s28, s28, 0x0
    s_addc_u32 s29, s29, 0
    s_cmp_eq_u32 s31, 3
    s_cselect_b32 s24, s60, s28
    s_cselect_b32 s25, s61, s29
    s_and_b32 s25, s25, 0xffff
    s_mov_b32 s27, 0x00020000
    s_mov_b32 s26, 0x4000000
    s_cmp_eq_u32 s31, 3
    s_cselect_b32 s26, 5120000, s26
    v_lshrrev_b32 v3, 5, v1
    v_bfe_u32 v8, v1, 2, 2
    v_lshl_add_u32 v3, v3, 3, v8
    v_lshlrev_b32 v3, 8, v3
    v_bfe_u32 v9, v1, 4, 1
    v_lshl_add_u32 v3, v9, 5, v3
    v_and_b32 v9, 3, v1
    v_lshl_add_u32 v3, v9, 3, v3
    s_and_b32 s45, s34, 1
    s_lshl_b32 s45, s45, 1
    s_lshr_b32 s53, s34, 1
    s_lshl_b32 s53, s53, 14
    s_cmp_eq_u32 s36, 0
    s_cselect_b32 s54, s34, s45
    s_cselect_b32 s62, 0, s53
    s_add_u32 s45, s45, 1
    s_cmp_eq_u32 s36, 0
    s_cselect_b32 s45, s34, s45
    s_cselect_b32 s53, 0x4000, s53
    v_xor_b32 v9, s45, v8
    v_xor_b32 v8, s54, v8
    v_lshl_add_u32 v8, v8, 6, v3
    v_lshl_add_u32 v9, v9, 6, v3
    v_add_u32 v8, s62, v8
    v_add_u32 v9, s53, v9
    v_add_u32 v50, 0x10000, v8
    v_add_u32 v51, 0x10000, v9
    v_and_b32 v3, 31, v1
    v_lshrrev_b32 v10, 5, v1
    v_and_b32 v11, 15, v1
    v_xor_b32 v10, v10, v11
    v_lshlrev_b32 v10, 4, v10
    v_lshl_add_u32 v10, v3, 9, v10
    v_xor_b32 v40, 0, v10
    v_xor_b32 v41, 32, v10
    v_xor_b32 v42, 64, v10
    v_xor_b32 v43, 96, v10
    v_xor_b32 v44, 128, v10
    v_xor_b32 v45, 160, v10
    v_xor_b32 v46, 192, v10
    v_xor_b32 v47, 224, v10
    s_mul_i32 s43, s33, 4608
    s_mov_b32 s45, 0
    s_cmp_eq_u32 s33, 7
    s_cselect_b32 s45, 49664, s45
    s_add_u32 s43, s43, s45
    v_lshrrev_b32 v11, 5, v1
    v_lshlrev_b32 v11, 3, v11
    v_mul_u32_u24 v10, 144, v3
    v_add3_u32 v10, v10, v11, s43
    v_lshrrev_b32 v11, 3, v1
    v_mul_u32_u24 v11, 144, v11
    v_and_b32 v12, 7, v1
    v_lshlrev_b32 v12, 4, v12
    v_add3_u32 v11, v11, v12, s43
    v_lshlrev_b32 v12, 4, v1
    v_lshrrev_b32 v14, 3, v1
    v_lshlrev_b32 v14, 9, v14
    v_and_b32 v15, 7, v1
    v_lshl_add_u32 v14, v15, 4, v14
    s_cmp_eq_u32 s31, 3
    s_cselect_b64 s[62:63], -1, 0
    s_cselect_b32 s56, 14, 12
    s_movk_i32 s57, 0x400
    s_cselect_b32 s57, 0x1000, s57
    s_nop 0
    v_cndmask_b32 v12, v12, v14, s[62:63]
    s_lshl_b32 s49, s37, 2
    s_add_u32 s49, s49, s34
    s_mul_i32 s49, s49, 1310720
    s_mul_i32 s45, s34, 1310720
    s_add_u32 s45, s45, 10485760
    s_cmp_eq_u32 s31, 2
    s_cselect_b32 s49, s45, s49
    s_lshl_b32 s45, s34, 7
    s_cmp_eq_u32 s31, 3
    s_cselect_b32 s49, s45, s49
    s_mov_b32 s50, 0xbfb8aa3b
    s_mov_b32 s51, 0xff7f0000
    v_mov_b32 v13, 0x7f7f0000
    s_cmp_eq_u32 s35, 0
    s_cbranch_scc0 L_gemm_np
    s_setprio 1
    L_gemm_np:
    s_add_u32 s43, s47, 98304
    v_add_u32 v16, s43, v40
    v_add_u32 v17, s43, v41
    v_add_u32 v18, s43, v42
    v_add_u32 v19, s43, v43
    v_add_u32 v20, s43, v44
    v_add_u32 v21, s43, v45
    v_add_u32 v22, s43, v46
    v_add_u32 v23, s43, v47
    s_waitcnt vmcnt(6) lgkmcnt(0)
    s_barrier
    ds_read_b64_tr_b16 v[64:65], v8 offset:0
    ds_read_b64_tr_b16 v[128:129], v9 offset:0
    ds_read_b64_tr_b16 v[66:67], v8 offset:1024
    ds_read_b64_tr_b16 v[130:131], v9 offset:1024
    ds_read_b64_tr_b16 v[68:69], v8 offset:4096
    ds_read_b64_tr_b16 v[132:133], v9 offset:4096
    ds_read_b64_tr_b16 v[70:71], v8 offset:5120
    ds_read_b64_tr_b16 v[134:135], v9 offset:5120
    s_waitcnt lgkmcnt(6)
    ds_read_b64_tr_b16 v[72:73], v8 offset:8192
    ds_read_b64_tr_b16 v[136:137], v9 offset:8192
    ds_read_b64_tr_b16 v[74:75], v8 offset:9216
    ds_read_b64_tr_b16 v[138:139], v9 offset:9216
    ds_read_b64_tr_b16 v[76:77], v8 offset:12288
    ds_read_b64_tr_b16 v[140:141], v9 offset:12288
    ds_read_b64_tr_b16 v[78:79], v8 offset:13312
    ds_read_b64_tr_b16 v[142:143], v9 offset:13312
    ds_read_b128 v[224:227], v16 offset:0
    ds_read_b128 v[228:231], v17 offset:0
    ds_read_b128 v[232:235], v18 offset:0
    ds_read_b128 v[236:239], v19 offset:0
    s_add_u32 m0, s41, 65536
    s_add_u32 s43, s42, 65536
    buffer_load_dwordx4 v2, s[12:15], s43 offen lds
    s_add_u32 m0, s41, 81920
    s_add_u32 s43, s39, 65536
    buffer_load_dwordx4 v2, s[16:19], s43 offen lds
    s_add_u32 m0, s41, 73728
    s_add_u32 s43, s42, 81920
    buffer_load_dwordx4 v2, s[12:15], s43 offen lds
    s_add_u32 m0, s41, 90112
    s_add_u32 s43, s39, 81920
    buffer_load_dwordx4 v2, s[16:19], s43 offen lds
    s_waitcnt vmcnt(6) lgkmcnt(0)
    s_barrier
    v_mfma_f32_32x32x16_bf16 v[192:207], v[64:67], v[224:227], 0
    ds_read_b64_tr_b16 v[80:81], v8 offset:32768
    ds_read_b64_tr_b16 v[144:145], v9 offset:32768
    v_mfma_f32_32x32x16_bf16 v[208:223], v[128:131], v[224:227], 0
    ds_read_b64_tr_b16 v[82:83], v8 offset:33792
    ds_read_b64_tr_b16 v[146:147], v9 offset:33792
    v_mfma_f32_32x32x16_bf16 v[192:207], v[68:71], v[228:231], v[192:207]
    ds_read_b64_tr_b16 v[84:85], v8 offset:36864
    ds_read_b64_tr_b16 v[148:149], v9 offset:36864
    v_mfma_f32_32x32x16_bf16 v[208:223], v[132:135], v[228:231], v[208:223]
    ds_read_b64_tr_b16 v[86:87], v8 offset:37888
    ds_read_b64_tr_b16 v[150:151], v9 offset:37888
    v_mfma_f32_32x32x16_bf16 v[192:207], v[72:75], v[232:235], v[192:207]
    ds_read_b64_tr_b16 v[88:89], v8 offset:40960
    ds_read_b64_tr_b16 v[152:153], v9 offset:40960
    v_mfma_f32_32x32x16_bf16 v[208:223], v[136:139], v[232:235], v[208:223]
    ds_read_b64_tr_b16 v[90:91], v8 offset:41984
    ds_read_b64_tr_b16 v[154:155], v9 offset:41984
    s_waitcnt lgkmcnt(6)
    v_mfma_f32_32x32x16_bf16 v[192:207], v[76:79], v[236:239], v[192:207]
    ds_read_b64_tr_b16 v[92:93], v8 offset:45056
    ds_read_b64_tr_b16 v[156:157], v9 offset:45056
    v_mfma_f32_32x32x16_bf16 v[208:223], v[140:143], v[236:239], v[208:223]
    ds_read_b64_tr_b16 v[94:95], v8 offset:46080
    ds_read_b64_tr_b16 v[158:159], v9 offset:46080
    ds_read_b128 v[224:227], v20 offset:0
    ds_read_b128 v[228:231], v21 offset:0
    ds_read_b128 v[232:235], v22 offset:0
    ds_read_b128 v[236:239], v23 offset:0
    s_add_u32 m0, s41, 0
    s_add_u32 s43, s42, 98304
    buffer_load_dwordx4 v2, s[12:15], s43 offen lds
    s_add_u32 m0, s41, 16384
    s_add_u32 s43, s39, 98304
    buffer_load_dwordx4 v2, s[16:19], s43 offen lds
    s_add_u32 m0, s41, 8192
    s_add_u32 s43, s42, 114688
    buffer_load_dwordx4 v2, s[12:15], s43 offen lds
    s_add_u32 m0, s41, 24576
    s_add_u32 s43, s39, 114688
    buffer_load_dwordx4 v2, s[16:19], s43 offen lds
    s_barrier
    s_add_u32 s45, s44, 2
    s_lshl_b32 s45, s45, 14
    s_add_u32 s45, s45, s46
    s_add_u32 s48, s46, s47
    s_add_u32 m0, s48, 131072
    s_add_u32 s43, s45, 0
    buffer_load_dwordx4 v4, s[20:23], s43 offen lds
    s_add_u32 m0, s48, 132096
    s_add_u32 s43, s45, 1024
    buffer_load_dwordx4 v5, s[20:23], s43 offen lds
    s_add_u32 m0, s48, 133120
    s_add_u32 s43, s45, 2048
    buffer_load_dwordx4 v6, s[20:23], s43 offen lds
    s_add_u32 m0, s48, 134144
    s_add_u32 s43, s45, 3072
    buffer_load_dwordx4 v7, s[20:23], s43 offen lds
    s_waitcnt vmcnt(8) lgkmcnt(0)
    s_barrier
    v_mfma_f32_32x32x16_bf16 v[192:207], v[80:83], v[224:227], v[192:207]
    ds_read_b64_tr_b16 v[96:97], v50 offset:0
    ds_read_b64_tr_b16 v[160:161], v51 offset:0
    v_mfma_f32_32x32x16_bf16 v[208:223], v[144:147], v[224:227], v[208:223]
    ds_read_b64_tr_b16 v[98:99], v50 offset:1024
    ds_read_b64_tr_b16 v[162:163], v51 offset:1024
    v_mfma_f32_32x32x16_bf16 v[192:207], v[84:87], v[228:231], v[192:207]
    ds_read_b64_tr_b16 v[100:101], v50 offset:4096
    ds_read_b64_tr_b16 v[164:165], v51 offset:4096
    v_mfma_f32_32x32x16_bf16 v[208:223], v[148:151], v[228:231], v[208:223]
    ds_read_b64_tr_b16 v[102:103], v50 offset:5120
    ds_read_b64_tr_b16 v[166:167], v51 offset:5120
    v_mfma_f32_32x32x16_bf16 v[192:207], v[88:91], v[232:235], v[192:207]
    ds_read_b64_tr_b16 v[104:105], v50 offset:8192
    ds_read_b64_tr_b16 v[168:169], v51 offset:8192
    v_mfma_f32_32x32x16_bf16 v[208:223], v[152:155], v[232:235], v[208:223]
    ds_read_b64_tr_b16 v[106:107], v50 offset:9216
    ds_read_b64_tr_b16 v[170:171], v51 offset:9216
    s_waitcnt lgkmcnt(6)
    v_mfma_f32_32x32x16_bf16 v[192:207], v[92:95], v[236:239], v[192:207]
    ds_read_b64_tr_b16 v[108:109], v50 offset:12288
    ds_read_b64_tr_b16 v[172:173], v51 offset:12288
    v_mfma_f32_32x32x16_bf16 v[208:223], v[156:159], v[236:239], v[208:223]
    ds_read_b64_tr_b16 v[110:111], v50 offset:13312
    ds_read_b64_tr_b16 v[174:175], v51 offset:13312
    ds_read_b128 v[224:227], v16 offset:256
    ds_read_b128 v[228:231], v17 offset:256
    ds_read_b128 v[232:235], v18 offset:256
    ds_read_b128 v[236:239], v19 offset:256
    s_add_u32 s45, s44, 4
    s_lshl_b32 s45, s45, 14
    s_add_u32 s45, s45, s46
    s_add_u32 s48, s46, s47
    s_add_u32 m0, s48, 32768
    s_add_u32 s43, s45, 0
    buffer_load_dwordx4 v4, s[20:23], s43 offen lds
    s_add_u32 m0, s48, 33792
    s_add_u32 s43, s45, 1024
    buffer_load_dwordx4 v5, s[20:23], s43 offen lds
    s_add_u32 m0, s48, 34816
    s_add_u32 s43, s45, 2048
    buffer_load_dwordx4 v6, s[20:23], s43 offen lds
    s_add_u32 m0, s48, 35840
    s_add_u32 s43, s45, 3072
    buffer_load_dwordx4 v7, s[20:23], s43 offen lds
    s_waitcnt vmcnt(8) lgkmcnt(0)
    s_barrier
    v_mfma_f32_32x32x16_bf16 v[192:207], v[96:99], v[224:227], v[192:207]
    ds_read_b64_tr_b16 v[112:113], v8 offset:0
    ds_read_b64_tr_b16 v[176:177], v9 offset:0
    v_mfma_f32_32x32x16_bf16 v[208:223], v[160:163], v[224:227], v[208:223]
    ds_read_b64_tr_b16 v[114:115], v8 offset:1024
    ds_read_b64_tr_b16 v[178:179], v9 offset:1024
    v_mfma_f32_32x32x16_bf16 v[192:207], v[100:103], v[228:231], v[192:207]
    ds_read_b64_tr_b16 v[116:117], v8 offset:4096
    ds_read_b64_tr_b16 v[180:181], v9 offset:4096
    v_mfma_f32_32x32x16_bf16 v[208:223], v[164:167], v[228:231], v[208:223]
    ds_read_b64_tr_b16 v[118:119], v8 offset:5120
    ds_read_b64_tr_b16 v[182:183], v9 offset:5120
    v_mfma_f32_32x32x16_bf16 v[192:207], v[104:107], v[232:235], v[192:207]
    ds_read_b64_tr_b16 v[120:121], v8 offset:8192
    ds_read_b64_tr_b16 v[184:185], v9 offset:8192
    v_mfma_f32_32x32x16_bf16 v[208:223], v[168:171], v[232:235], v[208:223]
    ds_read_b64_tr_b16 v[122:123], v8 offset:9216
    ds_read_b64_tr_b16 v[186:187], v9 offset:9216
    s_waitcnt lgkmcnt(6)
    v_mfma_f32_32x32x16_bf16 v[192:207], v[108:111], v[236:239], v[192:207]
    ds_read_b64_tr_b16 v[124:125], v8 offset:12288
    ds_read_b64_tr_b16 v[188:189], v9 offset:12288
    v_mfma_f32_32x32x16_bf16 v[208:223], v[172:175], v[236:239], v[208:223]
    ds_read_b64_tr_b16 v[126:127], v8 offset:13312
    ds_read_b64_tr_b16 v[190:191], v9 offset:13312
    ds_read_b128 v[224:227], v20 offset:256
    ds_read_b128 v[228:231], v21 offset:256
    ds_read_b128 v[232:235], v22 offset:256
    ds_read_b128 v[236:239], v23 offset:256
    s_cmp_eq_u32 s35, 1
    s_cbranch_scc1 L_nox3_1
    s_add_u32 s45, s44, 6
    s_lshl_b32 s45, s45, 14
    s_add_u32 s45, s45, s46
    s_add_u32 s48, s46, s47
    s_add_u32 m0, s48, 65536
    s_add_u32 s43, s45, 0
    buffer_load_dwordx4 v4, s[20:23], s43 offen lds
    s_add_u32 m0, s48, 66560
    s_add_u32 s43, s45, 1024
    buffer_load_dwordx4 v5, s[20:23], s43 offen lds
    s_add_u32 m0, s48, 67584
    s_add_u32 s43, s45, 2048
    buffer_load_dwordx4 v6, s[20:23], s43 offen lds
    s_add_u32 m0, s48, 68608
    s_add_u32 s43, s45, 3072
    buffer_load_dwordx4 v7, s[20:23], s43 offen lds
L_nox3_1:
    s_waitcnt lgkmcnt(0)
    v_mfma_f32_32x32x16_bf16 v[192:207], v[112:115], v[224:227], v[192:207]
    v_mfma_f32_32x32x16_bf16 v[208:223], v[176:179], v[224:227], v[208:223]
    v_mfma_f32_32x32x16_bf16 v[192:207], v[116:119], v[228:231], v[192:207]
    v_mfma_f32_32x32x16_bf16 v[208:223], v[180:183], v[228:231], v[208:223]
    v_mfma_f32_32x32x16_bf16 v[192:207], v[120:123], v[232:235], v[192:207]
    v_mfma_f32_32x32x16_bf16 v[208:223], v[184:187], v[232:235], v[208:223]
    v_mfma_f32_32x32x16_bf16 v[192:207], v[124:127], v[236:239], v[192:207]
    v_mfma_f32_32x32x16_bf16 v[208:223], v[188:191], v[236:239], v[208:223]
    s_cmp_eq_u32 s35, 0
    s_cbranch_scc1 L_w1_2
    s_waitcnt vmcnt(4)
    s_branch L_w2_3
    L_w1_2:
    s_waitcnt vmcnt(8)
    L_w2_3:
    s_barrier
    s_nop 7
    s_nop 7
    s_cmp_eq_u32 s31, 3
    s_cbranch_scc1 L_ep_u_4
    v_mul_f32 v192, s50, v192
    v_mul_f32 v193, s50, v193
    v_mul_f32 v194, s50, v194
    v_mul_f32 v195, s50, v195
    v_mul_f32 v196, s50, v196
    v_mul_f32 v197, s50, v197
    v_mul_f32 v198, s50, v198
    v_mul_f32 v199, s50, v199
    v_mul_f32 v200, s50, v200
    v_mul_f32 v201, s50, v201
    v_mul_f32 v202, s50, v202
    v_mul_f32 v203, s50, v203
    v_mul_f32 v204, s50, v204
    v_mul_f32 v205, s50, v205
    v_mul_f32 v206, s50, v206
    v_mul_f32 v207, s50, v207
    s_cmp_eq_u32 s31, 2
    s_cbranch_scc1 L_ep_a_5
    v_rcp_f32 v208, v208
    v_rcp_f32 v209, v209
    v_rcp_f32 v210, v210
    v_rcp_f32 v211, v211
    v_rcp_f32 v212, v212
    v_rcp_f32 v213, v213
    v_rcp_f32 v214, v214
    v_rcp_f32 v215, v215
    v_rcp_f32 v216, v216
    v_rcp_f32 v217, v217
    v_rcp_f32 v218, v218
    v_rcp_f32 v219, v219
    v_rcp_f32 v220, v220
    v_rcp_f32 v221, v221
    v_rcp_f32 v222, v222
    v_rcp_f32 v223, v223
    s_nop 0
    v_med3_f32 v208, v208, s51, v13
    v_med3_f32 v209, v209, s51, v13
    v_med3_f32 v210, v210, s51, v13
    v_med3_f32 v211, v211, s51, v13
    v_med3_f32 v212, v212, s51, v13
    v_med3_f32 v213, v213, s51, v13
    v_med3_f32 v214, v214, s51, v13
    v_med3_f32 v215, v215, s51, v13
    v_med3_f32 v216, v216, s51, v13
    v_med3_f32 v217, v217, s51, v13
    v_med3_f32 v218, v218, s51, v13
    v_med3_f32 v219, v219, s51, v13
    v_med3_f32 v220, v220, s51, v13
    v_med3_f32 v221, v221, s51, v13
    v_med3_f32 v222, v222, s51, v13
    v_med3_f32 v223, v223, s51, v13
    s_branch L_ep_u_4
L_ep_a_5:
    v_mul_f32 v208, s50, v208
    v_mul_f32 v209, s50, v209
    v_mul_f32 v210, s50, v210
    v_mul_f32 v211, s50, v211
    v_mul_f32 v212, s50, v212
    v_mul_f32 v213, s50, v213
    v_mul_f32 v214, s50, v214
    v_mul_f32 v215, s50, v215
    v_mul_f32 v216, s50, v216
    v_mul_f32 v217, s50, v217
    v_mul_f32 v218, s50, v218
    v_mul_f32 v219, s50, v219
    v_mul_f32 v220, s50, v220
    v_mul_f32 v221, s50, v221
    v_mul_f32 v222, s50, v222
    v_mul_f32 v223, s50, v223
L_ep_u_4:
    v_cvt_pk_bf16_f32 v24, v192, v193
    v_cvt_pk_bf16_f32 v25, v194, v195
    v_cvt_pk_bf16_f32 v32, v208, v209
    v_cvt_pk_bf16_f32 v33, v210, v211
    v_cvt_pk_bf16_f32 v26, v196, v197
    v_cvt_pk_bf16_f32 v27, v198, v199
    v_cvt_pk_bf16_f32 v34, v212, v213
    v_cvt_pk_bf16_f32 v35, v214, v215
    v_cvt_pk_bf16_f32 v28, v200, v201
    v_cvt_pk_bf16_f32 v29, v202, v203
    v_cvt_pk_bf16_f32 v36, v216, v217
    v_cvt_pk_bf16_f32 v37, v218, v219
    v_cvt_pk_bf16_f32 v30, v204, v205
    v_cvt_pk_bf16_f32 v31, v206, v207
    v_cvt_pk_bf16_f32 v38, v220, v221
    v_cvt_pk_bf16_f32 v39, v222, v223
    ds_write_b64 v10, v[24:25] offset:0
    ds_write_b64 v10, v[32:33] offset:64
    ds_write_b64 v10, v[26:27] offset:16
    ds_write_b64 v10, v[34:35] offset:80
    ds_write_b64 v10, v[28:29] offset:32
    ds_write_b64 v10, v[36:37] offset:96
    ds_write_b64 v10, v[30:31] offset:48
    ds_write_b64 v10, v[38:39] offset:112
    s_waitcnt lgkmcnt(0)
    ds_read_b128 v[24:27], v11 offset:0
    ds_read_b128 v[28:31], v11 offset:1152
    ds_read_b128 v[32:35], v11 offset:2304
    ds_read_b128 v[36:39], v11 offset:3456
    s_lshl_b32 s43, s44, s56
    s_add_u32 s43, s43, s49
    s_waitcnt lgkmcnt(0)
    buffer_store_dwordx4 v[24:27], v12, s[24:27], s43 offen sc1
    s_add_u32 s43, s43, s57
    buffer_store_dwordx4 v[28:31], v12, s[24:27], s43 offen sc1
    s_add_u32 s43, s43, s57
    buffer_store_dwordx4 v[32:35], v12, s[24:27], s43 offen sc1
    s_add_u32 s43, s43, s57
    buffer_store_dwordx4 v[36:39], v12, s[24:27], s43 offen sc1
    s_add_u32 s44, s44, 2
    s_add_u32 s43, s47, 131072
    v_add_u32 v16, s43, v40
    v_add_u32 v17, s43, v41
    v_add_u32 v18, s43, v42
    v_add_u32 v19, s43, v43
    v_add_u32 v20, s43, v44
    v_add_u32 v21, s43, v45
    v_add_u32 v22, s43, v46
    v_add_u32 v23, s43, v47
    ds_read_b128 v[224:227], v16 offset:0
    ds_read_b128 v[228:231], v17 offset:0
    ds_read_b128 v[232:235], v18 offset:0
    ds_read_b128 v[236:239], v19 offset:0
    s_waitcnt lgkmcnt(3)
    v_mfma_f32_32x32x16_bf16 v[192:207], v[64:67], v[224:227], 0
    v_mfma_f32_32x32x16_bf16 v[208:223], v[128:131], v[224:227], 0
    ds_read_b128 v[224:227], v20 offset:0
    s_waitcnt lgkmcnt(3)
    v_mfma_f32_32x32x16_bf16 v[192:207], v[68:71], v[228:231], v[192:207]
    v_mfma_f32_32x32x16_bf16 v[208:223], v[132:135], v[228:231], v[208:223]
    ds_read_b128 v[228:231], v21 offset:0
    s_waitcnt lgkmcnt(3)
    v_mfma_f32_32x32x16_bf16 v[192:207], v[72:75], v[232:235], v[192:207]
    v_mfma_f32_32x32x16_bf16 v[208:223], v[136:139], v[232:235], v[208:223]
    ds_read_b128 v[232:235], v22 offset:0
    s_waitcnt lgkmcnt(3)
    v_mfma_f32_32x32x16_bf16 v[192:207], v[76:79], v[236:239], v[192:207]
    v_mfma_f32_32x32x16_bf16 v[208:223], v[140:143], v[236:239], v[208:223]
    ds_read_b128 v[236:239], v23 offset:0
    s_waitcnt lgkmcnt(3)
    v_mfma_f32_32x32x16_bf16 v[192:207], v[80:83], v[224:227], v[192:207]
    v_mfma_f32_32x32x16_bf16 v[208:223], v[144:147], v[224:227], v[208:223]
    ds_read_b128 v[224:227], v16 offset:256
    s_waitcnt lgkmcnt(3)
    v_mfma_f32_32x32x16_bf16 v[192:207], v[84:87], v[228:231], v[192:207]
    v_mfma_f32_32x32x16_bf16 v[208:223], v[148:151], v[228:231], v[208:223]
    ds_read_b128 v[228:231], v17 offset:256
    s_waitcnt lgkmcnt(3)
    v_mfma_f32_32x32x16_bf16 v[192:207], v[88:91], v[232:235], v[192:207]
    v_mfma_f32_32x32x16_bf16 v[208:223], v[152:155], v[232:235], v[208:223]
    ds_read_b128 v[232:235], v18 offset:256
    s_waitcnt lgkmcnt(3)
    v_mfma_f32_32x32x16_bf16 v[192:207], v[92:95], v[236:239], v[192:207]
    v_mfma_f32_32x32x16_bf16 v[208:223], v[156:159], v[236:239], v[208:223]
    ds_read_b128 v[236:239], v19 offset:256
    s_waitcnt lgkmcnt(3)
    v_mfma_f32_32x32x16_bf16 v[192:207], v[96:99], v[224:227], v[192:207]
    v_mfma_f32_32x32x16_bf16 v[208:223], v[160:163], v[224:227], v[208:223]
    ds_read_b128 v[224:227], v20 offset:256
    s_waitcnt lgkmcnt(3)
    v_mfma_f32_32x32x16_bf16 v[192:207], v[100:103], v[228:231], v[192:207]
    v_mfma_f32_32x32x16_bf16 v[208:223], v[164:167], v[228:231], v[208:223]
    ds_read_b128 v[228:231], v21 offset:256
    s_waitcnt lgkmcnt(3)
    v_mfma_f32_32x32x16_bf16 v[192:207], v[104:107], v[232:235], v[192:207]
    v_mfma_f32_32x32x16_bf16 v[208:223], v[168:171], v[232:235], v[208:223]
    ds_read_b128 v[232:235], v22 offset:256
    s_waitcnt lgkmcnt(3)
    v_mfma_f32_32x32x16_bf16 v[192:207], v[108:111], v[236:239], v[192:207]
    v_mfma_f32_32x32x16_bf16 v[208:223], v[172:175], v[236:239], v[208:223]
    ds_read_b128 v[236:239], v23 offset:256
    s_waitcnt lgkmcnt(3)
    v_mfma_f32_32x32x16_bf16 v[192:207], v[112:115], v[224:227], v[192:207]
    v_mfma_f32_32x32x16_bf16 v[208:223], v[176:179], v[224:227], v[208:223]
    s_waitcnt lgkmcnt(2)
    v_mfma_f32_32x32x16_bf16 v[192:207], v[116:119], v[228:231], v[192:207]
    v_mfma_f32_32x32x16_bf16 v[208:223], v[180:183], v[228:231], v[208:223]
    s_waitcnt lgkmcnt(1)
    v_mfma_f32_32x32x16_bf16 v[192:207], v[120:123], v[232:235], v[192:207]
    v_mfma_f32_32x32x16_bf16 v[208:223], v[184:187], v[232:235], v[208:223]
    s_waitcnt lgkmcnt(0)
    v_mfma_f32_32x32x16_bf16 v[192:207], v[124:127], v[236:239], v[192:207]
    v_mfma_f32_32x32x16_bf16 v[208:223], v[188:191], v[236:239], v[208:223]
    s_nop 7
    s_nop 7
    s_cmp_eq_u32 s31, 3
    s_cbranch_scc1 L_ep_u_6
    v_mul_f32 v192, s50, v192
    v_mul_f32 v193, s50, v193
    v_mul_f32 v194, s50, v194
    v_mul_f32 v195, s50, v195
    v_mul_f32 v196, s50, v196
    v_mul_f32 v197, s50, v197
    v_mul_f32 v198, s50, v198
    v_mul_f32 v199, s50, v199
    v_mul_f32 v200, s50, v200
    v_mul_f32 v201, s50, v201
    v_mul_f32 v202, s50, v202
    v_mul_f32 v203, s50, v203
    v_mul_f32 v204, s50, v204
    v_mul_f32 v205, s50, v205
    v_mul_f32 v206, s50, v206
    v_mul_f32 v207, s50, v207
    s_cmp_eq_u32 s31, 2
    s_cbranch_scc1 L_ep_a_7
    v_rcp_f32 v208, v208
    v_rcp_f32 v209, v209
    v_rcp_f32 v210, v210
    v_rcp_f32 v211, v211
    v_rcp_f32 v212, v212
    v_rcp_f32 v213, v213
    v_rcp_f32 v214, v214
    v_rcp_f32 v215, v215
    v_rcp_f32 v216, v216
    v_rcp_f32 v217, v217
    v_rcp_f32 v218, v218
    v_rcp_f32 v219, v219
    v_rcp_f32 v220, v220
    v_rcp_f32 v221, v221
    v_rcp_f32 v222, v222
    v_rcp_f32 v223, v223
    s_nop 0
    v_med3_f32 v208, v208, s51, v13
    v_med3_f32 v209, v209, s51, v13
    v_med3_f32 v210, v210, s51, v13
    v_med3_f32 v211, v211, s51, v13
    v_med3_f32 v212, v212, s51, v13
    v_med3_f32 v213, v213, s51, v13
    v_med3_f32 v214, v214, s51, v13
    v_med3_f32 v215, v215, s51, v13
    v_med3_f32 v216, v216, s51, v13
    v_med3_f32 v217, v217, s51, v13
    v_med3_f32 v218, v218, s51, v13
    v_med3_f32 v219, v219, s51, v13
    v_med3_f32 v220, v220, s51, v13
    v_med3_f32 v221, v221, s51, v13
    v_med3_f32 v222, v222, s51, v13
    v_med3_f32 v223, v223, s51, v13
    s_branch L_ep_u_6
L_ep_a_7:
    v_mul_f32 v208, s50, v208
    v_mul_f32 v209, s50, v209
    v_mul_f32 v210, s50, v210
    v_mul_f32 v211, s50, v211
    v_mul_f32 v212, s50, v212
    v_mul_f32 v213, s50, v213
    v_mul_f32 v214, s50, v214
    v_mul_f32 v215, s50, v215
    v_mul_f32 v216, s50, v216
    v_mul_f32 v217, s50, v217
    v_mul_f32 v218, s50, v218
    v_mul_f32 v219, s50, v219
    v_mul_f32 v220, s50, v220
    v_mul_f32 v221, s50, v221
    v_mul_f32 v222, s50, v222
    v_mul_f32 v223, s50, v223
L_ep_u_6:
    v_cvt_pk_bf16_f32 v24, v192, v193
    v_cvt_pk_bf16_f32 v25, v194, v195
    v_cvt_pk_bf16_f32 v32, v208, v209
    v_cvt_pk_bf16_f32 v33, v210, v211
    v_cvt_pk_bf16_f32 v26, v196, v197
    v_cvt_pk_bf16_f32 v27, v198, v199
    v_cvt_pk_bf16_f32 v34, v212, v213
    v_cvt_pk_bf16_f32 v35, v214, v215
    v_cvt_pk_bf16_f32 v28, v200, v201
    v_cvt_pk_bf16_f32 v29, v202, v203
    v_cvt_pk_bf16_f32 v36, v216, v217
    v_cvt_pk_bf16_f32 v37, v218, v219
    v_cvt_pk_bf16_f32 v30, v204, v205
    v_cvt_pk_bf16_f32 v31, v206, v207
    v_cvt_pk_bf16_f32 v38, v220, v221
    v_cvt_pk_bf16_f32 v39, v222, v223
    ds_write_b64 v10, v[24:25] offset:0
    ds_write_b64 v10, v[32:33] offset:64
    ds_write_b64 v10, v[26:27] offset:16
    ds_write_b64 v10, v[34:35] offset:80
    ds_write_b64 v10, v[28:29] offset:32
    ds_write_b64 v10, v[36:37] offset:96
    ds_write_b64 v10, v[30:31] offset:48
    ds_write_b64 v10, v[38:39] offset:112
    s_waitcnt lgkmcnt(0)
    ds_read_b128 v[24:27], v11 offset:0
    ds_read_b128 v[28:31], v11 offset:1152
    ds_read_b128 v[32:35], v11 offset:2304
    ds_read_b128 v[36:39], v11 offset:3456
    s_lshl_b32 s43, s44, s56
    s_add_u32 s43, s43, s49
    s_waitcnt lgkmcnt(0)
    buffer_store_dwordx4 v[24:27], v12, s[24:27], s43 offen sc1
    s_add_u32 s43, s43, s57
    buffer_store_dwordx4 v[28:31], v12, s[24:27], s43 offen sc1
    s_add_u32 s43, s43, s57
    buffer_store_dwordx4 v[32:35], v12, s[24:27], s43 offen sc1
    s_add_u32 s43, s43, s57
    buffer_store_dwordx4 v[36:39], v12, s[24:27], s43 offen sc1
    s_add_u32 s44, s44, 2
    s_waitcnt vmcnt(8)
    s_barrier
    s_add_u32 s43, s47, 32768
    v_add_u32 v16, s43, v40
    v_add_u32 v17, s43, v41
    v_add_u32 v18, s43, v42
    v_add_u32 v19, s43, v43
    v_add_u32 v20, s43, v44
    v_add_u32 v21, s43, v45
    v_add_u32 v22, s43, v46
    v_add_u32 v23, s43, v47
    ds_read_b128 v[224:227], v16 offset:0
    ds_read_b128 v[228:231], v17 offset:0
    ds_read_b128 v[232:235], v18 offset:0
    ds_read_b128 v[236:239], v19 offset:0
    s_waitcnt lgkmcnt(3)
    v_mfma_f32_32x32x16_bf16 v[192:207], v[64:67], v[224:227], 0
    v_mfma_f32_32x32x16_bf16 v[208:223], v[128:131], v[224:227], 0
    ds_read_b128 v[224:227], v20 offset:0
    s_waitcnt lgkmcnt(3)
    v_mfma_f32_32x32x16_bf16 v[192:207], v[68:71], v[228:231], v[192:207]
    v_mfma_f32_32x32x16_bf16 v[208:223], v[132:135], v[228:231], v[208:223]
    ds_read_b128 v[228:231], v21 offset:0
    s_waitcnt lgkmcnt(3)
    v_mfma_f32_32x32x16_bf16 v[192:207], v[72:75], v[232:235], v[192:207]
    v_mfma_f32_32x32x16_bf16 v[208:223], v[136:139], v[232:235], v[208:223]
    ds_read_b128 v[232:235], v22 offset:0
    s_waitcnt lgkmcnt(3)
    v_mfma_f32_32x32x16_bf16 v[192:207], v[76:79], v[236:239], v[192:207]
    v_mfma_f32_32x32x16_bf16 v[208:223], v[140:143], v[236:239], v[208:223]
    ds_read_b128 v[236:239], v23 offset:0
    s_waitcnt lgkmcnt(3)
    v_mfma_f32_32x32x16_bf16 v[192:207], v[80:83], v[224:227], v[192:207]
    v_mfma_f32_32x32x16_bf16 v[208:223], v[144:147], v[224:227], v[208:223]
    ds_read_b128 v[224:227], v16 offset:256
    s_waitcnt lgkmcnt(3)
    v_mfma_f32_32x32x16_bf16 v[192:207], v[84:87], v[228:231], v[192:207]
    v_mfma_f32_32x32x16_bf16 v[208:223], v[148:151], v[228:231], v[208:223]
    ds_read_b128 v[228:231], v17 offset:256
    s_waitcnt lgkmcnt(3)
    v_mfma_f32_32x32x16_bf16 v[192:207], v[88:91], v[232:235], v[192:207]
    v_mfma_f32_32x32x16_bf16 v[208:223], v[152:155], v[232:235], v[208:223]
    ds_read_b128 v[232:235], v18 offset:256
    s_waitcnt lgkmcnt(3)
    v_mfma_f32_32x32x16_bf16 v[192:207], v[92:95], v[236:239], v[192:207]
    v_mfma_f32_32x32x16_bf16 v[208:223], v[156:159], v[236:239], v[208:223]
    ds_read_b128 v[236:239], v19 offset:256
    s_waitcnt lgkmcnt(3)
    v_mfma_f32_32x32x16_bf16 v[192:207], v[96:99], v[224:227], v[192:207]
    v_mfma_f32_32x32x16_bf16 v[208:223], v[160:163], v[224:227], v[208:223]
    ds_read_b128 v[224:227], v20 offset:256
    s_waitcnt lgkmcnt(3)
    v_mfma_f32_32x32x16_bf16 v[192:207], v[100:103], v[228:231], v[192:207]
    v_mfma_f32_32x32x16_bf16 v[208:223], v[164:167], v[228:231], v[208:223]
    ds_read_b128 v[228:231], v21 offset:256
    s_waitcnt lgkmcnt(3)
    v_mfma_f32_32x32x16_bf16 v[192:207], v[104:107], v[232:235], v[192:207]
    v_mfma_f32_32x32x16_bf16 v[208:223], v[168:171], v[232:235], v[208:223]
    ds_read_b128 v[232:235], v22 offset:256
    s_waitcnt lgkmcnt(3)
    v_mfma_f32_32x32x16_bf16 v[192:207], v[108:111], v[236:239], v[192:207]
    v_mfma_f32_32x32x16_bf16 v[208:223], v[172:175], v[236:239], v[208:223]
    ds_read_b128 v[236:239], v23 offset:256
    s_waitcnt lgkmcnt(3)
    v_mfma_f32_32x32x16_bf16 v[192:207], v[112:115], v[224:227], v[192:207]
    v_mfma_f32_32x32x16_bf16 v[208:223], v[176:179], v[224:227], v[208:223]
    s_waitcnt lgkmcnt(2)
    v_mfma_f32_32x32x16_bf16 v[192:207], v[116:119], v[228:231], v[192:207]
    v_mfma_f32_32x32x16_bf16 v[208:223], v[180:183], v[228:231], v[208:223]
    s_waitcnt lgkmcnt(1)
    v_mfma_f32_32x32x16_bf16 v[192:207], v[120:123], v[232:235], v[192:207]
    v_mfma_f32_32x32x16_bf16 v[208:223], v[184:187], v[232:235], v[208:223]
    s_waitcnt lgkmcnt(0)
    v_mfma_f32_32x32x16_bf16 v[192:207], v[124:127], v[236:239], v[192:207]
    v_mfma_f32_32x32x16_bf16 v[208:223], v[188:191], v[236:239], v[208:223]
    s_nop 7
    s_nop 7
    s_cmp_eq_u32 s31, 3
    s_cbranch_scc1 L_ep_u_8
    v_mul_f32 v192, s50, v192
    v_mul_f32 v193, s50, v193
    v_mul_f32 v194, s50, v194
    v_mul_f32 v195, s50, v195
    v_mul_f32 v196, s50, v196
    v_mul_f32 v197, s50, v197
    v_mul_f32 v198, s50, v198
    v_mul_f32 v199, s50, v199
    v_mul_f32 v200, s50, v200
    v_mul_f32 v201, s50, v201
    v_mul_f32 v202, s50, v202
    v_mul_f32 v203, s50, v203
    v_mul_f32 v204, s50, v204
    v_mul_f32 v205, s50, v205
    v_mul_f32 v206, s50, v206
    v_mul_f32 v207, s50, v207
    s_cmp_eq_u32 s31, 2
    s_cbranch_scc1 L_ep_a_9
    v_rcp_f32 v208, v208
    v_rcp_f32 v209, v209
    v_rcp_f32 v210, v210
    v_rcp_f32 v211, v211
    v_rcp_f32 v212, v212
    v_rcp_f32 v213, v213
    v_rcp_f32 v214, v214
    v_rcp_f32 v215, v215
    v_rcp_f32 v216, v216
    v_rcp_f32 v217, v217
    v_rcp_f32 v218, v218
    v_rcp_f32 v219, v219
    v_rcp_f32 v220, v220
    v_rcp_f32 v221, v221
    v_rcp_f32 v222, v222
    v_rcp_f32 v223, v223
    s_nop 0
    v_med3_f32 v208, v208, s51, v13
    v_med3_f32 v209, v209, s51, v13
    v_med3_f32 v210, v210, s51, v13
    v_med3_f32 v211, v211, s51, v13
    v_med3_f32 v212, v212, s51, v13
    v_med3_f32 v213, v213, s51, v13
    v_med3_f32 v214, v214, s51, v13
    v_med3_f32 v215, v215, s51, v13
    v_med3_f32 v216, v216, s51, v13
    v_med3_f32 v217, v217, s51, v13
    v_med3_f32 v218, v218, s51, v13
    v_med3_f32 v219, v219, s51, v13
    v_med3_f32 v220, v220, s51, v13
    v_med3_f32 v221, v221, s51, v13
    v_med3_f32 v222, v222, s51, v13
    v_med3_f32 v223, v223, s51, v13
    s_branch L_ep_u_8
L_ep_a_9:
    v_mul_f32 v208, s50, v208
    v_mul_f32 v209, s50, v209
    v_mul_f32 v210, s50, v210
    v_mul_f32 v211, s50, v211
    v_mul_f32 v212, s50, v212
    v_mul_f32 v213, s50, v213
    v_mul_f32 v214, s50, v214
    v_mul_f32 v215, s50, v215
    v_mul_f32 v216, s50, v216
    v_mul_f32 v217, s50, v217
    v_mul_f32 v218, s50, v218
    v_mul_f32 v219, s50, v219
    v_mul_f32 v220, s50, v220
    v_mul_f32 v221, s50, v221
    v_mul_f32 v222, s50, v222
    v_mul_f32 v223, s50, v223
L_ep_u_8:
    v_cvt_pk_bf16_f32 v24, v192, v193
    v_cvt_pk_bf16_f32 v25, v194, v195
    v_cvt_pk_bf16_f32 v32, v208, v209
    v_cvt_pk_bf16_f32 v33, v210, v211
    v_cvt_pk_bf16_f32 v26, v196, v197
    v_cvt_pk_bf16_f32 v27, v198, v199
    v_cvt_pk_bf16_f32 v34, v212, v213
    v_cvt_pk_bf16_f32 v35, v214, v215
    v_cvt_pk_bf16_f32 v28, v200, v201
    v_cvt_pk_bf16_f32 v29, v202, v203
    v_cvt_pk_bf16_f32 v36, v216, v217
    v_cvt_pk_bf16_f32 v37, v218, v219
    v_cvt_pk_bf16_f32 v30, v204, v205
    v_cvt_pk_bf16_f32 v31, v206, v207
    v_cvt_pk_bf16_f32 v38, v220, v221
    v_cvt_pk_bf16_f32 v39, v222, v223
    ds_write_b64 v10, v[24:25] offset:0
    ds_write_b64 v10, v[32:33] offset:64
    ds_write_b64 v10, v[26:27] offset:16
    ds_write_b64 v10, v[34:35] offset:80
    ds_write_b64 v10, v[28:29] offset:32
    ds_write_b64 v10, v[36:37] offset:96
    ds_write_b64 v10, v[30:31] offset:48
    ds_write_b64 v10, v[38:39] offset:112
    s_waitcnt lgkmcnt(0)
    ds_read_b128 v[24:27], v11 offset:0
    ds_read_b128 v[28:31], v11 offset:1152
    ds_read_b128 v[32:35], v11 offset:2304
    ds_read_b128 v[36:39], v11 offset:3456
    s_lshl_b32 s43, s44, s56
    s_add_u32 s43, s43, s49
    s_waitcnt lgkmcnt(0)
    buffer_store_dwordx4 v[24:27], v12, s[24:27], s43 offen sc1
    s_add_u32 s43, s43, s57
    buffer_store_dwordx4 v[28:31], v12, s[24:27], s43 offen sc1
    s_add_u32 s43, s43, s57
    buffer_store_dwordx4 v[32:35], v12, s[24:27], s43 offen sc1
    s_add_u32 s43, s43, s57
    buffer_store_dwordx4 v[36:39], v12, s[24:27], s43 offen sc1
    s_add_u32 s44, s44, 2
    s_cmp_eq_u32 s35, 1
    s_cbranch_scc1 L_gemm_done
    s_add_u32 s43, s47, 65536
    v_add_u32 v16, s43, v40
    v_add_u32 v17, s43, v41
    v_add_u32 v18, s43, v42
    v_add_u32 v19, s43, v43
    v_add_u32 v20, s43, v44
    v_add_u32 v21, s43, v45
    v_add_u32 v22, s43, v46
    v_add_u32 v23, s43, v47
    ds_read_b128 v[224:227], v16 offset:0
    ds_read_b128 v[228:231], v17 offset:0
    ds_read_b128 v[232:235], v18 offset:0
    ds_read_b128 v[236:239], v19 offset:0
    s_waitcnt lgkmcnt(3)
    v_mfma_f32_32x32x16_bf16 v[192:207], v[64:67], v[224:227], 0
    v_mfma_f32_32x32x16_bf16 v[208:223], v[128:131], v[224:227], 0
    ds_read_b128 v[224:227], v20 offset:0
    s_waitcnt lgkmcnt(3)
    v_mfma_f32_32x32x16_bf16 v[192:207], v[68:71], v[228:231], v[192:207]
    v_mfma_f32_32x32x16_bf16 v[208:223], v[132:135], v[228:231], v[208:223]
    ds_read_b128 v[228:231], v21 offset:0
    s_waitcnt lgkmcnt(3)
    v_mfma_f32_32x32x16_bf16 v[192:207], v[72:75], v[232:235], v[192:207]
    v_mfma_f32_32x32x16_bf16 v[208:223], v[136:139], v[232:235], v[208:223]
    ds_read_b128 v[232:235], v22 offset:0
    s_waitcnt lgkmcnt(3)
    v_mfma_f32_32x32x16_bf16 v[192:207], v[76:79], v[236:239], v[192:207]
    v_mfma_f32_32x32x16_bf16 v[208:223], v[140:143], v[236:239], v[208:223]
    ds_read_b128 v[236:239], v23 offset:0
    s_waitcnt lgkmcnt(3)
    v_mfma_f32_32x32x16_bf16 v[192:207], v[80:83], v[224:227], v[192:207]
    v_mfma_f32_32x32x16_bf16 v[208:223], v[144:147], v[224:227], v[208:223]
    ds_read_b128 v[224:227], v16 offset:256
    s_waitcnt lgkmcnt(3)
    v_mfma_f32_32x32x16_bf16 v[192:207], v[84:87], v[228:231], v[192:207]
    v_mfma_f32_32x32x16_bf16 v[208:223], v[148:151], v[228:231], v[208:223]
    ds_read_b128 v[228:231], v17 offset:256
    s_waitcnt lgkmcnt(3)
    v_mfma_f32_32x32x16_bf16 v[192:207], v[88:91], v[232:235], v[192:207]
    v_mfma_f32_32x32x16_bf16 v[208:223], v[152:155], v[232:235], v[208:223]
    ds_read_b128 v[232:235], v18 offset:256
    s_waitcnt lgkmcnt(3)
    v_mfma_f32_32x32x16_bf16 v[192:207], v[92:95], v[236:239], v[192:207]
    v_mfma_f32_32x32x16_bf16 v[208:223], v[156:159], v[236:239], v[208:223]
    ds_read_b128 v[236:239], v19 offset:256
    s_waitcnt lgkmcnt(3)
    v_mfma_f32_32x32x16_bf16 v[192:207], v[96:99], v[224:227], v[192:207]
    v_mfma_f32_32x32x16_bf16 v[208:223], v[160:163], v[224:227], v[208:223]
    ds_read_b128 v[224:227], v20 offset:256
    s_waitcnt lgkmcnt(3)
    v_mfma_f32_32x32x16_bf16 v[192:207], v[100:103], v[228:231], v[192:207]
    v_mfma_f32_32x32x16_bf16 v[208:223], v[164:167], v[228:231], v[208:223]
    ds_read_b128 v[228:231], v21 offset:256
    s_waitcnt lgkmcnt(3)
    v_mfma_f32_32x32x16_bf16 v[192:207], v[104:107], v[232:235], v[192:207]
    v_mfma_f32_32x32x16_bf16 v[208:223], v[168:171], v[232:235], v[208:223]
    ds_read_b128 v[232:235], v22 offset:256
    s_waitcnt lgkmcnt(3)
    v_mfma_f32_32x32x16_bf16 v[192:207], v[108:111], v[236:239], v[192:207]
    v_mfma_f32_32x32x16_bf16 v[208:223], v[172:175], v[236:239], v[208:223]
    ds_read_b128 v[236:239], v23 offset:256
    s_waitcnt lgkmcnt(3)
    v_mfma_f32_32x32x16_bf16 v[192:207], v[112:115], v[224:227], v[192:207]
    v_mfma_f32_32x32x16_bf16 v[208:223], v[176:179], v[224:227], v[208:223]
    s_waitcnt lgkmcnt(2)
    v_mfma_f32_32x32x16_bf16 v[192:207], v[116:119], v[228:231], v[192:207]
    v_mfma_f32_32x32x16_bf16 v[208:223], v[180:183], v[228:231], v[208:223]
    s_waitcnt lgkmcnt(1)
    v_mfma_f32_32x32x16_bf16 v[192:207], v[120:123], v[232:235], v[192:207]
    v_mfma_f32_32x32x16_bf16 v[208:223], v[184:187], v[232:235], v[208:223]
    s_waitcnt lgkmcnt(0)
    v_mfma_f32_32x32x16_bf16 v[192:207], v[124:127], v[236:239], v[192:207]
    v_mfma_f32_32x32x16_bf16 v[208:223], v[188:191], v[236:239], v[208:223]
    s_nop 7
    s_nop 7
    s_cmp_eq_u32 s31, 3
    s_cbranch_scc1 L_ep_u_10
    v_mul_f32 v192, s50, v192
    v_mul_f32 v193, s50, v193
    v_mul_f32 v194, s50, v194
    v_mul_f32 v195, s50, v195
    v_mul_f32 v196, s50, v196
    v_mul_f32 v197, s50, v197
    v_mul_f32 v198, s50, v198
    v_mul_f32 v199, s50, v199
    v_mul_f32 v200, s50, v200
    v_mul_f32 v201, s50, v201
    v_mul_f32 v202, s50, v202
    v_mul_f32 v203, s50, v203
    v_mul_f32 v204, s50, v204
    v_mul_f32 v205, s50, v205
    v_mul_f32 v206, s50, v206
    v_mul_f32 v207, s50, v207
    s_cmp_eq_u32 s31, 2
    s_cbranch_scc1 L_ep_a_11
    v_rcp_f32 v208, v208
    v_rcp_f32 v209, v209
    v_rcp_f32 v210, v210
    v_rcp_f32 v211, v211
    v_rcp_f32 v212, v212
    v_rcp_f32 v213, v213
    v_rcp_f32 v214, v214
    v_rcp_f32 v215, v215
    v_rcp_f32 v216, v216
    v_rcp_f32 v217, v217
    v_rcp_f32 v218, v218
    v_rcp_f32 v219, v219
    v_rcp_f32 v220, v220
    v_rcp_f32 v221, v221
    v_rcp_f32 v222, v222
    v_rcp_f32 v223, v223
    s_nop 0
    v_med3_f32 v208, v208, s51, v13
    v_med3_f32 v209, v209, s51, v13
    v_med3_f32 v210, v210, s51, v13
    v_med3_f32 v211, v211, s51, v13
    v_med3_f32 v212, v212, s51, v13
    v_med3_f32 v213, v213, s51, v13
    v_med3_f32 v214, v214, s51, v13
    v_med3_f32 v215, v215, s51, v13
    v_med3_f32 v216, v216, s51, v13
    v_med3_f32 v217, v217, s51, v13
    v_med3_f32 v218, v218, s51, v13
    v_med3_f32 v219, v219, s51, v13
    v_med3_f32 v220, v220, s51, v13
    v_med3_f32 v221, v221, s51, v13
    v_med3_f32 v222, v222, s51, v13
    v_med3_f32 v223, v223, s51, v13
    s_branch L_ep_u_10
L_ep_a_11:
    v_mul_f32 v208, s50, v208
    v_mul_f32 v209, s50, v209
    v_mul_f32 v210, s50, v210
    v_mul_f32 v211, s50, v211
    v_mul_f32 v212, s50, v212
    v_mul_f32 v213, s50, v213
    v_mul_f32 v214, s50, v214
    v_mul_f32 v215, s50, v215
    v_mul_f32 v216, s50, v216
    v_mul_f32 v217, s50, v217
    v_mul_f32 v218, s50, v218
    v_mul_f32 v219, s50, v219
    v_mul_f32 v220, s50, v220
    v_mul_f32 v221, s50, v221
    v_mul_f32 v222, s50, v222
    v_mul_f32 v223, s50, v223
L_ep_u_10:
    v_cvt_pk_bf16_f32 v24, v192, v193
    v_cvt_pk_bf16_f32 v25, v194, v195
    v_cvt_pk_bf16_f32 v32, v208, v209
    v_cvt_pk_bf16_f32 v33, v210, v211
    v_cvt_pk_bf16_f32 v26, v196, v197
    v_cvt_pk_bf16_f32 v27, v198, v199
    v_cvt_pk_bf16_f32 v34, v212, v213
    v_cvt_pk_bf16_f32 v35, v214, v215
    v_cvt_pk_bf16_f32 v28, v200, v201
    v_cvt_pk_bf16_f32 v29, v202, v203
    v_cvt_pk_bf16_f32 v36, v216, v217
    v_cvt_pk_bf16_f32 v37, v218, v219
    v_cvt_pk_bf16_f32 v30, v204, v205
    v_cvt_pk_bf16_f32 v31, v206, v207
    v_cvt_pk_bf16_f32 v38, v220, v221
    v_cvt_pk_bf16_f32 v39, v222, v223
    ds_write_b64 v10, v[24:25] offset:0
    ds_write_b64 v10, v[32:33] offset:64
    ds_write_b64 v10, v[26:27] offset:16
    ds_write_b64 v10, v[34:35] offset:80
    ds_write_b64 v10, v[28:29] offset:32
    ds_write_b64 v10, v[36:37] offset:96
    ds_write_b64 v10, v[30:31] offset:48
    ds_write_b64 v10, v[38:39] offset:112
    s_waitcnt lgkmcnt(0)
    ds_read_b128 v[24:27], v11 offset:0
    ds_read_b128 v[28:31], v11 offset:1152
    ds_read_b128 v[32:35], v11 offset:2304
    ds_read_b128 v[36:39], v11 offset:3456
    s_lshl_b32 s43, s44, s56
    s_add_u32 s43, s43, s49
    s_waitcnt lgkmcnt(0)
    buffer_store_dwordx4 v[24:27], v12, s[24:27], s43 offen sc1
    s_add_u32 s43, s43, s57
    buffer_store_dwordx4 v[28:31], v12, s[24:27], s43 offen sc1
    s_add_u32 s43, s43, s57
    buffer_store_dwordx4 v[32:35], v12, s[24:27], s43 offen sc1
    s_add_u32 s43, s43, s57
    buffer_store_dwordx4 v[36:39], v12, s[24:27], s43 offen sc1
    s_add_u32 s44, s44, 2
    s_branch L_gemm_done
L_gemm_spare:
    s_sub_u32 s30, s32, 45
    s_mul_i32 s33, s31, 3
    s_add_u32 s30, s30, s33
    v_lshrrev_b32 v2, 6, v0
    v_and_b32 v1, 63, v0
    v_readfirstlane_b32 s33, v2
    s_waitcnt lgkmcnt(0)
    s_mov_b32 s20, s4
    s_and_b32 s21, s5, 0xffff
    s_mov_b32 s22, 0x4e2000
    s_mov_b32 s23, 0x00020000
    s_lshr_b32 s34, s33, 1
    s_lshl2_add_u32 s34, s30, s34
    s_mul_i32 s34, s34, 7
    s_add_u32 s34, s34, 4
    s_lshl_b32 s34, s34, 14
    s_and_b32 s35, s33, 1
    s_mul_i32 s35, s35, 24576
    s_add_u32 s34, s34, s35
    v_lshlrev_b32 v3, 7, v1
    buffer_load_dword v4, v3, s[20:23], s34 offen
    s_add_u32 s34, s34, 8192
    buffer_load_dword v4, v3, s[20:23], s34 offen
    s_add_u32 s34, s34, 8192
    buffer_load_dword v4, v3, s[20:23], s34 offen
    s_endpgm
    L_gemm_done:
    s_endpgm
L_k1_misc:
    s_load_dwordx2 s[6:7], s[0:1], 48
    s_load_dwordx2 s[28:29], s[0:1], 72
    v_and_b32 v1, 63, v0
    v_lshrrev_b32 v2, 6, v0
    s_nop 0
    v_readfirstlane_b32 s33, v2
    s_waitcnt lgkmcnt(0)
    s_mov_b32 s12, s6
    s_and_b32 s13, s7, 0xffff
    s_mov_b32 s14, 0x42000
    s_mov_b32 s15, 0x00020000
    s_mov_b32 s24, s28
    s_and_b32 s25, s29, 0xffff
    s_mov_b32 s26, 0x4000000
    s_mov_b32 s27, 0x00020000
    v_lshrrev_b32 v3, 5, v1
    v_lshlrev_b32 v3, 12, v3
    v_and_b32 v4, 31, v1
    v_lshl_add_u32 v3, v4, 1, v3
    s_lshl_b32 s34, s33, 6
    s_add_u32 s34, s34, 262144
    buffer_load_ushort v8, v3, s[12:15], s34 offen offset:0
    buffer_load_ushort v9, v3, s[12:15], s34 offen offset:512
    buffer_load_ushort v10, v3, s[12:15], s34 offen offset:1024
    buffer_load_ushort v11, v3, s[12:15], s34 offen offset:1536
    buffer_load_ushort v12, v3, s[12:15], s34 offen offset:2048
    buffer_load_ushort v13, v3, s[12:15], s34 offen offset:2560
    buffer_load_ushort v14, v3, s[12:15], s34 offen offset:3072
    buffer_load_ushort v15, v3, s[12:15], s34 offen offset:3584
    s_mov_b32 s35, 0xbfb8aa3b
    s_waitcnt vmcnt(0)
    v_lshlrev_b32 v8, 16, v8
    v_mul_f32 v8, s35, v8
    v_lshlrev_b32 v9, 16, v9
    v_mul_f32 v9, s35, v9
    v_lshlrev_b32 v10, 16, v10
    v_mul_f32 v10, s35, v10
    v_lshlrev_b32 v11, 16, v11
    v_mul_f32 v11, s35, v11
    v_lshlrev_b32 v12, 16, v12
    v_mul_f32 v12, s35, v12
    v_lshlrev_b32 v13, 16, v13
    v_mul_f32 v13, s35, v13
    v_lshlrev_b32 v14, 16, v14
    v_mul_f32 v14, s35, v14
    v_lshlrev_b32 v15, 16, v15
    v_mul_f32 v15, s35, v15
    v_cvt_pk_bf16_f32 v16, v8, v9
    v_cvt_pk_bf16_f32 v17, v10, v11
    v_cvt_pk_bf16_f32 v18, v12, v13
    v_cvt_pk_bf16_f32 v19, v14, v15
    v_lshlrev_b32 v3, 4, v1
    s_lshl_b32 s34, s33, 10
    s_add_u32 s34, s34, 27000832
    buffer_store_dwordx4 v[16:19], v3, s[24:27], s34 offen
    s_cmp_eq_u32 s33, 0
    s_cbranch_scc0 L_misc_done
    v_and_b32 v21, 31, v1
    v_lshrrev_b32 v22, 5, v1
    v_lshlrev_b32 v23, 3, v22
    v_sub_u32 v24, v21, v23
    v_subrev_u32 v25, 16, v24
    v_mov_b32 v26, 0x3f80
    v_mov_b32 v27, 0x3f800000
    v_mov_b32 v28, 0
    v_cmp_eq_u32 s[44:45], 0, v24
    v_cmp_eq_u32 s[40:41], 1, v24
    s_nop 1
    v_cndmask_b32 v32, v28, v26, s[44:45]
    v_cndmask_b32 v32, v32, v27, s[40:41]
    v_cmp_eq_u32 s[44:45], 2, v24
    v_cmp_eq_u32 s[40:41], 3, v24
    s_nop 1
    v_cndmask_b32 v33, v28, v26, s[44:45]
    v_cndmask_b32 v33, v33, v27, s[40:41]
    v_cmp_eq_u32 s[44:45], 4, v24
    v_cmp_eq_u32 s[40:41], 5, v24
    s_nop 1
    v_cndmask_b32 v34, v28, v26, s[44:45]
    v_cndmask_b32 v34, v34, v27, s[40:41]
    v_cmp_eq_u32 s[44:45], 6, v24
    v_cmp_eq_u32 s[40:41], 7, v24
    s_nop 1
    v_cndmask_b32 v35, v28, v26, s[44:45]
    v_cndmask_b32 v35, v35, v27, s[40:41]
    v_cmp_eq_u32 s[44:45], 0, v25
    v_cmp_eq_u32 s[40:41], 1, v25
    s_nop 1
    v_cndmask_b32 v36, v28, v26, s[44:45]
    v_cndmask_b32 v36, v36, v27, s[40:41]
    v_cmp_eq_u32 s[44:45], 2, v25
    v_cmp_eq_u32 s[40:41], 3, v25
    s_nop 1
    v_cndmask_b32 v37, v28, v26, s[44:45]
    v_cndmask_b32 v37, v37, v27, s[40:41]
    v_cmp_eq_u32 s[44:45], 4, v25
    v_cmp_eq_u32 s[40:41], 5, v25
    s_nop 1
    v_cndmask_b32 v38, v28, v26, s[44:45]
    v_cndmask_b32 v38, v38, v27, s[40:41]
    v_cmp_eq_u32 s[44:45], 6, v25
    v_cmp_eq_u32 s[40:41], 7, v25
    s_nop 1
    v_cndmask_b32 v39, v28, v26, s[44:45]
    v_cndmask_b32 v39, v39, v27, s[40:41]
    v_bfe_u32 v23, v1, 1, 3
    v_xor_b32 v23, v23, v22
    v_lshlrev_b32 v23, 4, v23
    v_lshl_add_u32 v40, v21, 7, v23
    v_lshrrev_b32 v41, 4, v21
    v_lshlrev_b32 v41, 5, v41
    v_bfe_u32 v23, v21, 2, 1
    v_lshl_add_u32 v41, v23, 4, v41
    v_bfe_u32 v23, v21, 3, 1
    v_lshl_add_u32 v41, v23, 3, v41
    v_and_b32 v23, 3, v21
    v_lshl_add_u32 v41, v23, 1, v41
    v_add_u32 v41, 128, v41
    v_lshlrev_b32 v23, 4, v22
    v_mul_u32_u24 v42, 208, v21
    v_add_u32 v42, v42, v23
    v_mul_u32_u24 v43, 144, v21
    v_add_u32 v43, v43, v23
    v_lshlrev_b32 v3, 4, v1
    s_mov_b32 s34, 27009024
    buffer_store_dwordx4 v[32:35], v3, s[24:27], s34 offen
    buffer_store_dwordx4 v[36:39], v3, s[24:27], s34 offen offset:1024
    buffer_store_dwordx4 v[40:43], v3, s[24:27], s34 offen offset:2048
    L_misc_done:
    s_endpgm
L_k1_exit:
    s_endpgm
L_k1_end:
.globl egc_k2_kernel
.p2align 8
.type egc_k2_kernel,@function
egc_k2_kernel:
    s_cmp_ge_u32 s2, 256
    s_cbranch_scc1 L_k2_exit
    s_load_dwordx2 s[10:11], s[0:1], 72
    s_load_dwordx2 s[38:39], s[0:1], 56
    v_mov_b32 v192, v0
    v_lshrrev_b32 v193, 6, v0
    v_and_b32 v0, 63, v0
    v_readfirstlane_b32 s6, v193
    s_lshr_b32 s40, s2, 3
    s_and_b32 s41, s2, 1
    s_lshl1_add_u32 s4, s40, s41
    s_bfe_u32 s5, s2, 0x20001
    v_lshrrev_b32 v193, 3, v192
    v_and_b32 v194, 7, v192
    v_mul_u32_u24 v195, 1088, v193
    v_lshl_add_u32 v195, v194, 2, v195
    v_mul_u32_u24 v201, 20, v193
    v_lshl_add_u32 v201, v194, 2, v201
    v_add_u32 v201, 124160, v201
    s_lshl_b32 s37, s6, 13
    s_mov_b32 s46, 1310720
    v_and_b32 v204, 7, v0
    v_lshrrev_b32 v205, 4, v0
    v_xor_b32 v204, v204, v205
    v_lshlrev_b32 v17, 4, v204
    v_xor_b32 v19, 64, v17
    v_mov_b32 v21, v17
    v_mov_b32 v23, v19
    v_lshlrev_b32 v204, 4, v0
    s_lshl_b32 s43, s4, 4
    s_add_u32 s43, s43, 26869760
    s_mul_i32 s40, s5, 2621440
    s_waitcnt lgkmcnt(0)
    s_mov_b32 s24, s10
    s_and_b32 s25, s11, 0xffff
    s_mov_b32 s26, 0x4000000
    s_mov_b32 s27, 0x00020000
    buffer_load_dword v200, v195, s[24:27], s43 offen
    s_barrier
    s_cmp_gt_u32 s6, 4
    s_cbranch_scc1 L_k2_noct
    s_lshl_b32 s41, s5, 11
    s_add_u32 s41, s41, 27000832
    s_lshl_b32 s44, s6, 10
    s_add_u32 s41, s41, s44
    s_add_u32 s45, s44, 27006976
    s_cmp_lt_u32 s6, 2
    s_cselect_b32 s41, s41, s45
    s_add_u32 m0, s44, 127552
    s_nop 0
    buffer_load_dwordx4 v204, s[24:27], s41 offen lds
    L_k2_noct:
    s_mul_i32 s40, s5, 1310720
    s_add_u32 s41, s40, 10485760
    s_add_u32 s16, s10, s41
    s_addc_u32 s17, s11, 0
    s_and_b32 s17, s17, 0xffff
    s_or_b32 s17, s17, 0x800000
    s_mov_b32 s18, 10000
    s_mov_b32 s19, 0x00020000
    s_lshl_b32 s40, s40, 1
    s_add_u32 s12, s10, s40
    s_addc_u32 s13, s11, 0
    s_and_b32 s13, s13, 0xffff
    s_or_b32 s13, s13, 0x800000
    s_mov_b32 s14, 10000
    s_mov_b32 s15, 0x00020000
    s_add_u32 s20, s10, 0x1400000
    s_addc_u32 s21, s11, 0
    s_and_b32 s21, s21, 0xffff
    s_or_b32 s21, s21, 0x200000
    s_mov_b32 s22, 0x27100
    s_mov_b32 s23, 0x00020000
    v_mov_b32 v196, 0
    v_mov_b32 v197, 0
    v_mov_b32 v198, 0
    v_mov_b32 v199, 0
    s_mul_i32 s42, s6, 4160
    s_add_u32 s42, s42, 65536
    v_lshl_add_u32 v193, v0, 4, s42
    ds_write_b128 v193, v[196:199]
    ds_write_b128 v193, v[196:199] offset:1024
    ds_write_b128 v193, v[196:199] offset:2048
    ds_write_b128 v193, v[196:199] offset:3072
    s_mov_b64 exec, 15
    ds_write_b128 v193, v[196:199] offset:4096
    s_mov_b64 exec, -1
    v_lshlrev_b32 v193, 4, v192
    v_add_u32 v193, 98816, v193
    ds_write_b128 v193, v[196:199]
    v_cmp_gt_u32 vcc, 280, v192
    s_and_saveexec_b64 s[40:41], vcc
    s_cbranch_execz L_k2_z1
    ds_write_b128 v193, v[196:199] offset:8192
    L_k2_z1:
    s_mov_b64 exec, s[40:41]
    v_lshrrev_b32 v194, 5, v0
    v_lshlrev_b32 v25, 4, v194
    v_mov_b32 v7, v25
    v_mov_b32 v10, 0x3f80
    v_mov_b32 v11, 0
    v_lshlrev_b32 v208, 2, v0
    v_lshrrev_b32 v202, 3, v192
    v_mul_u32_u24 v202, 2500, v202
    s_cmp_gt_u32 s6, 4
    s_cbranch_scc1 L_k2_w_12
    s_waitcnt vmcnt(1)
    s_branch L_k2_w_13
    L_k2_w_12:
    s_waitcnt vmcnt(0)
    L_k2_w_13:
    v_and_b32 v195, 0xffff, v200
    v_add_u32 v202, v202, v195
    v_mov_b32 v203, v195
    v_lshlrev_b32 v205, 2, v202
    v_mov_b32_dpp v203, v195 row_shl:4 row_mask:0xf bank_mask:0xf
    v_add_u32 v205, 26214400, v205
    v_sub_u32 v203, v203, v195
    v_and_b32 v194, 7, v192
    v_cmp_gt_u32 vcc, 5, v194
    v_readlane_b32 s92, v205, 0
    v_readlane_b32 s93, v205, 8
    v_readlane_b32 s94, v205, 16
    v_readlane_b32 s95, v205, 24
    v_readlane_b32 s96, v205, 32
    v_readlane_b32 s97, v205, 40
    v_readlane_b32 s98, v205, 48
    v_readlane_b32 s99, v205, 56
    s_and_saveexec_b64 s[44:45], vcc
    ds_write_b32 v201, v200
    s_mov_b64 exec, s[44:45]
    buffer_load_dword v128, v208, s[24:27], s92 offen
    buffer_load_dword v129, v208, s[24:27], s93 offen
    buffer_load_dword v130, v208, s[24:27], s94 offen
    buffer_load_dword v131, v208, s[24:27], s95 offen
    buffer_load_dword v132, v208, s[24:27], s96 offen
    buffer_load_dword v133, v208, s[24:27], s97 offen
    buffer_load_dword v134, v208, s[24:27], s98 offen
    buffer_load_dword v135, v208, s[24:27], s99 offen
    s_waitcnt lgkmcnt(0)
    s_barrier
    v_readlane_b32 s48, v202, 0
    v_readlane_b32 s56, v203, 0
    v_readlane_b32 s49, v202, 8
    v_readlane_b32 s57, v203, 8
    v_readlane_b32 s50, v202, 16
    v_readlane_b32 s58, v203, 16
    v_readlane_b32 s51, v202, 24
    v_readlane_b32 s59, v203, 24
    v_readlane_b32 s52, v202, 32
    v_readlane_b32 s60, v203, 32
    v_readlane_b32 s53, v202, 40
    v_readlane_b32 s61, v203, 40
    v_readlane_b32 s54, v202, 48
    v_readlane_b32 s62, v203, 48
    v_readlane_b32 s55, v202, 56
    v_readlane_b32 s63, v203, 56
    v_mov_b32 v84, 0
    v_mov_b32 v85, 0
    v_mov_b32 v86, 0
    v_mov_b32 v87, 0
    v_mov_b32 v88, 0
    v_mov_b32 v89, 0
    v_mov_b32 v90, 0
    v_mov_b32 v91, 0
    s_mov_b32 s32, 0
    s_mov_b32 s3, 1
L_k2_round:
    v_mul_u32_u24 v198, 20, v0
    v_add_u32 v198, 124160, v198
    s_lshl_b32 s40, s6, 1
    v_add_u32 v199, s40, v198
    ds_read_u16 v192, v198
    ds_read_u16 v193, v198 offset:16
    ds_read_u16 v194, v199
    ds_read_u16 v195, v199 offset:2
    s_movk_i32 s33, 64
L_k2_r1:
    v_cmp_le_u32 s[44:45], s32, v0
    v_cmp_gt_u32 s[40:41], s33, v0
    s_waitcnt lgkmcnt(0)
    s_and_b64 s[44:45], s[44:45], s[40:41]
    v_sub_u32 v196, v195, v194
    v_cndmask_b32 v196, 0, v196, s[44:45]
    v_mov_b32 v197, v196
    s_nop 1
    v_add_u32_dpp v197, v197, v197 row_shr:1 row_mask:0xf bank_mask:0xf bound_ctrl:0
    s_nop 1
    v_add_u32_dpp v197, v197, v197 row_shr:2 row_mask:0xf bank_mask:0xf bound_ctrl:0
    s_nop 1
    v_add_u32_dpp v197, v197, v197 row_shr:4 row_mask:0xf bank_mask:0xf bound_ctrl:0
    s_nop 1
    v_add_u32_dpp v197, v197, v197 row_shr:8 row_mask:0xf bank_mask:0xf bound_ctrl:0
    s_nop 1
    v_add_u32_dpp v197, v197, v197 row_bcast:15 row_mask:0xa bank_mask:0xf
    s_nop 1
    v_add_u32_dpp v197, v197, v197 row_bcast:31 row_mask:0xc bank_mask:0xf
    s_nop 1
    v_readlane_b32 s40, v197, 63
    v_sub_u32 v197, v197, v196
    v_sub_u32 v197, v197, v194
    v_add_u32 v197, v197, v192
    s_lshl2_add_u32 s41, s6, 127488
    v_mov_b32 v198, s41
    v_mov_b32 v199, s40
    ds_write_b32 v198, v199
    v_and_b32 v146, 7, v0
    v_lshlrev_b32 v147, 2, v146
    v_add_u32 v147, 127488, v147
    v_lshrrev_b32 v148, 3, v0
    v_lshlrev_b32 v149, 2, v148
    v_add_u32 v149, 127488, v149
    s_mul_i32 s41, s6, 384
    v_add_u32 v152, s41, v197
    v_lshlrev_b32 v152, 1, v152
    v_add_u32 v152, 98816, v152
    s_lshl2_add_u32 s41, s6, 125440
    v_lshl_add_u32 v153, v0, 5, s41
    ds_write_b32 v153, v152
    s_waitcnt vmcnt(8) lgkmcnt(0)
    s_barrier
    ds_read_b32 v144, v147
    ds_read_b32 v145, v149
    s_waitcnt lgkmcnt(0)
    v_cmp_lt_u32 vcc, 384, v144
    v_mul_u32_u24 v151, 384, v146
    s_mov_b32 s47, 1
    s_nop 2
    s_cmp_eq_u64 vcc, 0
    s_cbranch_scc0 L_k2_slowlb
    L_k2_r3:
    s_cmp_eq_u32 s3, 0
    s_cbranch_scc1 L_k2_noassign
    v_lshlrev_b32 v152, 3, v144
    v_sub_u32 v152, v152, v146
    v_lshlrev_b32 v153, 3, v145
    v_sub_u32 v153, v153, v148
    v_add_u32 v152, 7, v152
    v_add_u32 v153, 7, v153
    v_cmp_gt_u32 s[44:45], v152, v153
    v_lshlrev_b32 v154, 3, v0
    s_sub_u32 s40, 11, s6
    s_cmp_lt_u32 s6, 4
    s_cselect_b32 s40, s6, s40
    v_lshrrev_b64 v[156:157], v154, s[44:45]
    v_and_b32 v156, 0xff, v156
    v_bcnt_u32_b32 v156, v156, 0
    v_cmp_eq_u32 vcc, s40, v156
    s_nop 3
    s_ff1_i32_b64 s68, vcc
    s_lshl3_add_u32 s7, s4, s68
    s_mul_i32 s40, s7, 625
    s_add_u32 s41, s40, 31
    s_lshr_b32 s8, s41, 5
    s_add_u32 s41, s40, 656
    s_lshr_b32 s41, s41, 5
    s_sub_u32 s9, s41, s8
    s_mul_i32 s42, s6, 4160
    s_add_u32 s42, s42, 65536
    v_add_u32 v7, s42, v7
    v_lshrrev_b32 v204, 3, v0
    v_add_u32 v16, s8, v204
    v_add_u32 v18, 8, v16
    v_add_u32 v20, 16, v16
    s_lshl_b32 s40, s5, 7
    s_add_u32 s28, s38, s40
    s_addc_u32 s29, s39, 0
    s_and_b32 s29, s29, 0xffff
    s_or_b32 s29, s29, 0x2000000
    s_mov_b32 s30, 10000
    s_mov_b32 s31, 0x00020000
    s_mul_i32 s43, s6, 3072
    s_add_u32 s43, s43, 132736
    s_add_u32 m0, s43, 0
    s_nop 0
    buffer_load_dwordx4 v[16:17], s[16:19], 0 idxen offen lds
    s_add_u32 m0, s43, 1024
    s_nop 0
    buffer_load_dwordx4 v[18:19], s[16:19], 0 idxen offen lds
    s_add_u32 m0, s43, 2048
    s_nop 0
    buffer_load_dwordx4 v[20:21], s[16:19], 0 idxen offen lds
    s_add_u32 m0, s37, 4096
    s_nop 0
    buffer_load_dwordx4 v[16:17], s[28:31], 0 idxen offen lds
    s_add_u32 m0, s37, 5120
    s_nop 0
    buffer_load_dwordx4 v[18:19], s[28:31], 0 idxen offen lds
    s_add_u32 m0, s37, 6144
    s_nop 0
    buffer_load_dwordx4 v[20:21], s[28:31], 0 idxen offen lds
L_k2_noassign:
    v_readlane_b32 s34, v144, s68
    v_readlane_b32 s35, v151, s68
    s_cmp_eq_u32 s47, 1
    s_cbranch_scc1 L_k2_nob2
    s_waitcnt lgkmcnt(0)
    s_barrier
    L_k2_nob2:
    v_lshlrev_b32 v203, 1, v0
    v_lshlrev_b32 v208, 2, v0
    s_lshl_b32 s47, s6, 8
    s_add_u32 s47, s47, 125440
    s_mov_b32 s44, 0xfffeaf80
    s_cmp_eq_u32 s3, 1
    s_cbranch_scc0 L_k2_reload
L_k2_haverec:
    s_sub_u32 s40, s33, s32
    s_cmp_eq_u32 s40, 64
    s_cbranch_scc0 L_k2_mask
    s_mov_b64 s[92:93], s[56:57]
    s_mov_b64 s[94:95], s[58:59]
    s_mov_b64 s[96:97], s[60:61]
    s_mov_b64 s[98:99], s[62:63]
L_k2_masked:
    s_cmp_eq_u32 s3, 1
    s_cbranch_scc1 L_k2_w_14
    s_waitcnt vmcnt(0)
    L_k2_w_14:
    s_waitcnt vmcnt(6)
    v_bfe_u32 v136, v128, 28, 3
    v_lshl_add_u32 v136, v136, 2, s47
    ds_read_b32 v136, v136 offset:0
    v_bfe_u32 v137, v129, 28, 3
    v_lshl_add_u32 v137, v137, 2, s47
    ds_read_b32 v137, v137 offset:32
    v_bfe_u32 v138, v130, 28, 3
    v_lshl_add_u32 v138, v138, 2, s47
    ds_read_b32 v138, v138 offset:64
    v_bfe_u32 v139, v131, 28, 3
    v_lshl_add_u32 v139, v139, 2, s47
    ds_read_b32 v139, v139 offset:96
    v_bfe_u32 v140, v132, 28, 3
    v_lshl_add_u32 v140, v140, 2, s47
    ds_read_b32 v140, v140 offset:128
    v_bfe_u32 v141, v133, 28, 3
    v_lshl_add_u32 v141, v141, 2, s47
    ds_read_b32 v141, v141 offset:160
    v_bfe_u32 v142, v134, 28, 3
    v_lshl_add_u32 v142, v142, 2, s47
    ds_read_b32 v142, v142 offset:192
    v_bfe_u32 v143, v135, 28, 3
    v_lshl_add_u32 v143, v143, 2, s47
    ds_read_b32 v143, v143 offset:224
    s_waitcnt lgkmcnt(0)
    v_cmpx_gt_u32 vcc, s92, v0
    v_add_u32 v136, v136, v203
    ds_write_b16 v136, v128
    ds_write_b16_d16_hi v136, v128 offset:6336
    v_lshl_add_u32 v136, v136, 1, s44
    v_add_u32 v92, s48, v0
    ds_write_b32 v136, v92
    s_mov_b64 exec, -1
    v_cmpx_gt_u32 vcc, s93, v0
    v_add_u32 v137, v137, v203
    ds_write_b16 v137, v129
    ds_write_b16_d16_hi v137, v129 offset:6336
    v_lshl_add_u32 v137, v137, 1, s44
    v_add_u32 v92, s49, v0
    ds_write_b32 v137, v92
    s_mov_b64 exec, -1
    v_cmpx_gt_u32 vcc, s94, v0
    v_add_u32 v138, v138, v203
    ds_write_b16 v138, v130
    ds_write_b16_d16_hi v138, v130 offset:6336
    v_lshl_add_u32 v138, v138, 1, s44
    v_add_u32 v92, s50, v0
    ds_write_b32 v138, v92
    s_mov_b64 exec, -1
    v_cmpx_gt_u32 vcc, s95, v0
    v_add_u32 v139, v139, v203
    ds_write_b16 v139, v131
    ds_write_b16_d16_hi v139, v131 offset:6336
    v_lshl_add_u32 v139, v139, 1, s44
    v_add_u32 v92, s51, v0
    ds_write_b32 v139, v92
    s_mov_b64 exec, -1
    v_cmpx_gt_u32 vcc, s96, v0
    v_add_u32 v140, v140, v203
    ds_write_b16 v140, v132
    ds_write_b16_d16_hi v140, v132 offset:6336
    v_lshl_add_u32 v140, v140, 1, s44
    v_add_u32 v92, s52, v0
    ds_write_b32 v140, v92
    s_mov_b64 exec, -1
    v_cmpx_gt_u32 vcc, s97, v0
    v_add_u32 v141, v141, v203
    ds_write_b16 v141, v133
    ds_write_b16_d16_hi v141, v133 offset:6336
    v_lshl_add_u32 v141, v141, 1, s44
    v_add_u32 v92, s53, v0
    ds_write_b32 v141, v92
    s_mov_b64 exec, -1
    v_cmpx_gt_u32 vcc, s98, v0
    v_add_u32 v142, v142, v203
    ds_write_b16 v142, v134
    ds_write_b16_d16_hi v142, v134 offset:6336
    v_lshl_add_u32 v142, v142, 1, s44
    v_add_u32 v92, s54, v0
    ds_write_b32 v142, v92
    s_mov_b64 exec, -1
    v_cmpx_gt_u32 vcc, s99, v0
    v_add_u32 v143, v143, v203
    ds_write_b16 v143, v135
    ds_write_b16_d16_hi v143, v135 offset:6336
    v_lshl_add_u32 v143, v143, 1, s44
    v_add_u32 v92, s55, v0
    ds_write_b32 v143, v92
    s_mov_b64 exec, -1
    s_max_u32 s40, s92, s93
    s_max_u32 s40, s40, s94
    s_max_u32 s40, s40, s95
    s_max_u32 s40, s40, s96
    s_max_u32 s40, s40, s97
    s_max_u32 s40, s40, s98
    s_max_u32 s40, s40, s99
    s_cmp_le_u32 s40, 64
    s_cbranch_scc0 L_k2_slowrows
L_k2_pl_done:
    s_cmp_eq_u32 s3, 0
    s_cbranch_scc1 L_k2_ct_32
    v_lshlrev_b32 v204, 4, v0
    v_add_u32 v204, 127552, v204
    ds_read_b128 v[212:215], v204 offset:4096
    ds_read_b128 v[36:39], v204
    ds_read_b128 v[40:43], v204 offset:1024
    ds_read_b128 v[44:47], v204 offset:2048
    ds_read_b128 v[48:51], v204 offset:3072
    s_waitcnt lgkmcnt(0)
    v_add_u32 v12, s37, v212
    v_add_u32 v8, s42, v213
    v_add_u32 v9, s42, v214
    v_add_u32 v206, s42, v214
    v_add_u32 v9, 128, v9
    v_xor_b32 v13, 32, v12
    v_xor_b32 v14, 64, v12
    v_xor_b32 v15, 96, v12
    L_k2_ct_32:
    s_waitcnt lgkmcnt(0)
    s_barrier
    s_cmp_eq_u32 s34, 0
    s_cbranch_scc1 L_k2_empty
    s_mov_b32 s36, s34
    v_lshrrev_b32 v92, 3, v0
    v_add_u32 v92, s35, v92
    v_lshlrev_b32 v92, 1, v92
    v_add_u32 v1, 98816, v92
    v_and_b32 v92, 31, v0
    v_add_u32 v92, s35, v92
    v_lshlrev_b32 v93, 2, v92
    v_add_u32 v2, 111488, v93
    v_lshlrev_b32 v93, 1, v92
    v_add_u32 v3, 105152, v93
    ds_read_u16 v16, v1 offset:0
    ds_read_u16 v18, v1 offset:16
    ds_read_u16 v20, v1 offset:32
    ds_read_u16 v22, v1 offset:48
    v_add_u32 v1, 64, v1
    ds_read_b32 v24, v2
    ds_read_b32 v94, v2 offset:128
    ds_read_u16 v4, v3
    s_mov_b32 s14, 10000
    s_mov_b32 s22, 160000
    v_mov_b32 v60, 0
    v_mov_b32 v61, 0
    v_mov_b32 v62, 0
    v_mov_b32 v63, 0
    v_mov_b32 v64, 0
    v_mov_b32 v65, 0
    v_mov_b32 v66, 0
    v_mov_b32 v67, 0
    s_waitcnt lgkmcnt(0)
    s_add_u32 m0, s37, 0
    s_nop 0
    buffer_load_dwordx4 v[16:17], s[12:15], 0 idxen offen lds
    s_add_u32 m0, s37, 1024
    s_nop 0
    buffer_load_dwordx4 v[18:19], s[12:15], 0 idxen offen lds
    s_add_u32 m0, s37, 2048
    s_nop 0
    buffer_load_dwordx4 v[20:21], s[12:15], 0 idxen offen lds
    s_add_u32 m0, s37, 3072
    s_nop 0
    buffer_load_dwordx4 v[22:23], s[12:15], 0 idxen offen lds
    buffer_load_dwordx4 v[28:31], v[24:25], s[20:23], 0 idxen offen
    s_cmp_eq_u32 s3, 0
    s_cbranch_scc1 L_k2_fr_33
    s_mul_i32 s43, s6, 3072
    s_add_u32 s43, s43, 132736
    s_sub_u32 s43, s43, s37
    v_add_u32 v207, s43, v12
    v_xor_b32 v208, 32, v207
    v_xor_b32 v209, 64, v207
    v_xor_b32 v210, 96, v207
    s_waitcnt vmcnt(5)
    ds_read_b128 v[160:163], v12 offset:4096
    ds_read_b128 v[164:167], v13 offset:4096
    ds_read_b128 v[168:171], v14 offset:4096
    ds_read_b128 v[172:175], v15 offset:4096
    ds_read_b128 v[68:71], v207
    ds_read_b128 v[72:75], v208
    ds_read_b128 v[76:79], v209
    ds_read_b128 v[80:83], v210
    s_waitcnt lgkmcnt(4)
L_k2_fr_33:
    s_add_u32 m0, s37, 4096
    s_nop 0
    buffer_load_dwordx4 v[16:17], s[12:15], s46 idxen offen lds
    s_add_u32 m0, s37, 5120
    s_nop 0
    buffer_load_dwordx4 v[18:19], s[12:15], s46 idxen offen lds
    s_add_u32 m0, s37, 6144
    s_nop 0
    buffer_load_dwordx4 v[20:21], s[12:15], s46 idxen offen lds
    s_add_u32 m0, s37, 7168
    s_nop 0
    buffer_load_dwordx4 v[22:23], s[12:15], s46 idxen offen lds
    v_and_b32 v4, 0xfff, v4
    v_add_u32 v5, v4, v7
    v_add_u32 v6, v4, v8
    v_mov_b32 v24, v94
    s_cmp_gt_i32 s36, 32
    s_cselect_b32 s22, 160000, 0
    buffer_load_dwordx4 v[32:35], v[24:25], s[20:23], 0 idxen offen
    s_cmp_eq_u32 s3, 0
    s_cbranch_scc1 L_k2_nf_34
    s_waitcnt lgkmcnt(0)
    s_mov_b32 exec_lo, 0x000fffff
    s_mov_b32 exec_hi, 0x000fffff
    ds_write_b128 v206, v[68:71]
    ds_write_b128 v206, v[72:75] offset:32
    ds_write_b128 v206, v[76:79] offset:64
    ds_write_b128 v206, v[80:83] offset:96
    s_mov_b64 exec, -1
    v_mfma_f32_32x32x16_bf16 v[96:111], v[160:163], v[44:47], 0
    v_mfma_f32_32x32x16_bf16 v[112:127], v[168:171], v[44:47], 0
    v_mfma_f32_32x32x16_bf16 v[96:111], v[164:167], v[48:51], v[96:111]
    v_mfma_f32_32x32x16_bf16 v[112:127], v[172:175], v[48:51], v[112:127]
    s_mov_b32 s3, 0
L_k2_nf_34:
    ds_read_u16 v16, v1 offset:0
    ds_read_u16 v18, v1 offset:16
    ds_read_u16 v20, v1 offset:32
    ds_read_u16 v22, v1 offset:48
    v_add_u32 v1, 64, v1
    ds_read_b32 v24, v2 offset:256
    ds_read_u16 v4, v3 offset:64
    v_add_u32 v2, 384, v2
    v_add_u32 v3, 128, v3
    s_waitcnt vmcnt(5) lgkmcnt(0)
    ds_read_b128 v[68:71], v12 offset:0
    ds_read_b128 v[72:75], v13 offset:0
    ds_read_b128 v[76:79], v14 offset:0
    ds_read_b128 v[80:83], v15 offset:0
    ds_read_b128 v[52:55], v5 offset:0
    ds_read_b128 v[56:59], v5 offset:32
    v_mfma_f32_32x32x16_bf16 v[128:143], v[28:31], v[36:39], 0
    s_waitcnt lgkmcnt(0)
    v_mfma_f32_32x32x16_bf16 v[144:159], v[76:79], v[44:47], 0
    v_mfma_f32_32x32x16_bf16 v[128:143], v[52:55], v[44:47], v[128:143]
    v_mfma_f32_32x32x16_bf16 v[144:159], v[80:83], v[48:51], v[144:159]
    v_mfma_f32_32x32x16_bf16 v[128:143], v[56:59], v[48:51], v[128:143]
    v_mfma_f32_32x32x16_bf16 v[128:143], v[68:71], v[44:47], v[128:143]
    v_mfma_f32_32x32x16_bf16 v[128:143], v[72:75], v[48:51], v[128:143]
    s_cmp_gt_i32 s36, 32
    s_cselect_b32 s14, 10000, 0
    s_add_u32 m0, s37, 0
    s_nop 0
    buffer_load_dwordx4 v[16:17], s[12:15], 0 idxen offen lds
    s_add_u32 m0, s37, 1024
    s_nop 0
    buffer_load_dwordx4 v[18:19], s[12:15], 0 idxen offen lds
    s_add_u32 m0, s37, 2048
    s_nop 0
    buffer_load_dwordx4 v[20:21], s[12:15], 0 idxen offen lds
    s_add_u32 m0, s37, 3072
    s_nop 0
    buffer_load_dwordx4 v[22:23], s[12:15], 0 idxen offen lds
    s_nop 3
L_k2_main:
    s_cmp_gt_i32 s36, 96
    s_cbranch_scc0 L_k2_tile
    s_setprio 0
    s_waitcnt vmcnt(5) lgkmcnt(0)
    ds_read_b128 v[76:79], v14 offset:4096
    ds_read_b128 v[80:83], v15 offset:4096
    ds_read_b128 v[68:71], v12 offset:4096
    ds_read_b128 v[72:75], v13 offset:4096
    ds_read_b128 v[52:55], v5 offset:64
    ds_read_b128 v[56:59], v5 offset:96
    v_mfma_f32_32x32x16_bf16 v[112:127], v[60:63], v[84:87], v[112:127]
    v_exp_f32 v128, v128
    v_exp_f32 v129, v129
    v_exp_f32 v130, v130
    v_exp_f32 v131, v131
    v_mfma_f32_32x32x16_bf16 v[112:127], v[64:67], v[88:91], v[112:127]
    v_exp_f32 v132, v132
    v_exp_f32 v133, v133
    v_exp_f32 v134, v134
    v_exp_f32 v135, v135
    ds_write_b16 v6, v10
    ds_read_b128 v[60:63], v9
    ds_read_b128 v[64:67], v9 offset:32
    ds_write_b16 v6, v11
    v_mfma_f32_32x32x16_bf16 v[160:175], v[28:31], v[40:43], 0
    v_exp_f32 v136, v136
    v_exp_f32 v137, v137
    v_exp_f32 v138, v138
    v_exp_f32 v139, v139
    s_waitcnt lgkmcnt(9)
    v_mfma_f32_32x32x16_bf16 v[176:191], v[76:79], v[44:47], 0
    v_exp_f32 v140, v140
    v_exp_f32 v141, v141
    v_exp_f32 v142, v142
    v_exp_f32 v143, v143
    s_waitcnt lgkmcnt(6)
    s_add_u32 m0, s37, 4096
    s_setprio 1
    v_pk_fma_f32 v[128:129], v[128:129], v[144:145], v[144:145]
    v_pk_fma_f32 v[130:131], v[130:131], v[146:147], v[146:147]
    v_pk_fma_f32 v[132:133], v[132:133], v[148:149], v[148:149]
    v_pk_fma_f32 v[134:135], v[134:135], v[150:151], v[150:151]
    v_pk_fma_f32 v[136:137], v[136:137], v[152:153], v[152:153]
    v_pk_fma_f32 v[138:139], v[138:139], v[154:155], v[154:155]
    v_pk_fma_f32 v[140:141], v[140:141], v[156:157], v[156:157]
    v_pk_fma_f32 v[142:143], v[142:143], v[158:159], v[158:159]
    v_mfma_f32_32x32x16_bf16 v[176:191], v[80:83], v[48:51], v[176:191]
    v_rcp_f32 v128, v128
    v_rcp_f32 v129, v129
    buffer_load_dwordx4 v[16:17], s[12:15], s46 idxen offen lds
    v_rcp_f32 v130, v130
    v_rcp_f32 v131, v131
    s_waitcnt lgkmcnt(5)
    v_mfma_f32_32x32x16_bf16 v[160:175], v[52:55], v[44:47], v[160:175]
    v_rcp_f32 v132, v132
    v_rcp_f32 v133, v133
    s_add_u32 m0, s37, 5120
    v_rcp_f32 v134, v134
    v_rcp_f32 v135, v135
    buffer_load_dwordx4 v[18:19], s[12:15], s46 idxen offen lds
    s_waitcnt lgkmcnt(4)
    v_mfma_f32_32x32x16_bf16 v[160:175], v[56:59], v[48:51], v[160:175]
    v_rcp_f32 v136, v136
    v_rcp_f32 v137, v137
    v_rcp_f32 v138, v138
    v_rcp_f32 v139, v139
    s_add_u32 m0, s37, 6144
    v_mfma_f32_32x32x16_bf16 v[160:175], v[68:71], v[44:47], v[160:175]
    v_rcp_f32 v140, v140
    v_rcp_f32 v141, v141
    buffer_load_dwordx4 v[20:21], s[12:15], s46 idxen offen lds
    v_rcp_f32 v142, v142
    v_rcp_f32 v143, v143
    v_mfma_f32_32x32x16_bf16 v[160:175], v[72:75], v[48:51], v[160:175]
    v_cvt_pk_bf16_f32 v84, v128, v129
    v_cvt_pk_bf16_f32 v85, v130, v131
    s_add_u32 m0, s37, 7168
    v_cvt_pk_bf16_f32 v86, v132, v133
    v_cvt_pk_bf16_f32 v87, v134, v135
    buffer_load_dwordx4 v[22:23], s[12:15], s46 idxen offen lds
    v_cvt_pk_bf16_f32 v88, v136, v137
    buffer_load_dwordx4 v[28:31], v[24:25], s[20:23], 0 idxen offen
    ds_read_u16 v16, v1 offset:0
    ds_read_u16 v18, v1 offset:16
    ds_read_u16 v20, v1 offset:32
    ds_read_u16 v22, v1 offset:48
    v_cvt_pk_bf16_f32 v89, v138, v139
    v_cvt_pk_bf16_f32 v90, v140, v141
    v_cvt_pk_bf16_f32 v91, v142, v143
    v_add_u32 v1, 64, v1
    v_and_b32 v4, 0xfff, v4
    v_add_u32 v5, v4, v7
    v_add_u32 v6, v4, v8
    s_setprio 0
    s_waitcnt vmcnt(5) lgkmcnt(0)
    ds_read_b128 v[76:79], v14 offset:0
    ds_read_b128 v[80:83], v15 offset:0
    ds_read_b128 v[68:71], v12 offset:0
    ds_read_b128 v[72:75], v13 offset:0
    ds_read_b128 v[52:55], v5 offset:0
    ds_read_b128 v[56:59], v5 offset:32
    v_mfma_f32_32x32x16_bf16 v[96:111], v[60:63], v[84:87], v[96:111]
    v_exp_f32 v160, v160
    v_exp_f32 v161, v161
    v_exp_f32 v162, v162
    v_exp_f32 v163, v163
    v_mfma_f32_32x32x16_bf16 v[96:111], v[64:67], v[88:91], v[96:111]
    v_exp_f32 v164, v164
    v_exp_f32 v165, v165
    v_exp_f32 v166, v166
    v_exp_f32 v167, v167
    v_mfma_f32_32x32x16_bf16 v[128:143], v[32:35], v[36:39], 0
    v_exp_f32 v168, v168
    v_exp_f32 v169, v169
    v_exp_f32 v170, v170
    v_exp_f32 v171, v171
    s_waitcnt lgkmcnt(5)
    v_mfma_f32_32x32x16_bf16 v[144:159], v[76:79], v[44:47], 0
    v_exp_f32 v172, v172
    v_exp_f32 v173, v173
    v_exp_f32 v174, v174
    v_exp_f32 v175, v175
    s_waitcnt lgkmcnt(2)
    s_add_u32 m0, s37, 0
    s_setprio 1
    v_pk_fma_f32 v[160:161], v[160:161], v[176:177], v[176:177]
    v_pk_fma_f32 v[162:163], v[162:163], v[178:179], v[178:179]
    v_pk_fma_f32 v[164:165], v[164:165], v[180:181], v[180:181]
    v_pk_fma_f32 v[166:167], v[166:167], v[182:183], v[182:183]
    v_pk_fma_f32 v[168:169], v[168:169], v[184:185], v[184:185]
    v_pk_fma_f32 v[170:171], v[170:171], v[186:187], v[186:187]
    v_pk_fma_f32 v[172:173], v[172:173], v[188:189], v[188:189]
    v_pk_fma_f32 v[174:175], v[174:175], v[190:191], v[190:191]
    v_mfma_f32_32x32x16_bf16 v[144:159], v[80:83], v[48:51], v[144:159]
    v_rcp_f32 v160, v160
    v_rcp_f32 v161, v161
    buffer_load_dwordx4 v[16:17], s[12:15], 0 idxen offen lds
    v_rcp_f32 v162, v162
    v_rcp_f32 v163, v163
    s_waitcnt lgkmcnt(1)
    v_mfma_f32_32x32x16_bf16 v[128:143], v[52:55], v[44:47], v[128:143]
    v_rcp_f32 v164, v164
    v_rcp_f32 v165, v165
    s_add_u32 m0, s37, 1024
    v_rcp_f32 v166, v166
    v_rcp_f32 v167, v167
    buffer_load_dwordx4 v[18:19], s[12:15], 0 idxen offen lds
    s_waitcnt lgkmcnt(0)
    v_mfma_f32_32x32x16_bf16 v[128:143], v[56:59], v[48:51], v[128:143]
    v_rcp_f32 v168, v168
    v_rcp_f32 v169, v169
    ds_read_b32 v24, v2
    ds_read_u16 v4, v3
    v_rcp_f32 v170, v170
    v_rcp_f32 v171, v171
    s_add_u32 m0, s37, 2048
    v_mfma_f32_32x32x16_bf16 v[128:143], v[68:71], v[44:47], v[128:143]
    v_rcp_f32 v172, v172
    v_rcp_f32 v173, v173
    buffer_load_dwordx4 v[20:21], s[12:15], 0 idxen offen lds
    v_rcp_f32 v174, v174
    v_rcp_f32 v175, v175
    v_mfma_f32_32x32x16_bf16 v[128:143], v[72:75], v[48:51], v[128:143]
    v_cvt_pk_bf16_f32 v84, v160, v161
    v_cvt_pk_bf16_f32 v85, v162, v163
    s_add_u32 m0, s37, 3072
    v_cvt_pk_bf16_f32 v86, v164, v165
    v_cvt_pk_bf16_f32 v87, v166, v167
    buffer_load_dwordx4 v[22:23], s[12:15], 0 idxen offen lds
    v_cvt_pk_bf16_f32 v88, v168, v169
    v_cvt_pk_bf16_f32 v89, v170, v171
    v_cvt_pk_bf16_f32 v90, v172, v173
    v_cvt_pk_bf16_f32 v91, v174, v175
    v_add_u32 v2, 128, v2
    v_add_u32 v3, 64, v3
    s_sub_i32 s36, s36, 32
    s_setprio 0
    s_waitcnt vmcnt(5) lgkmcnt(0)
    ds_read_b128 v[76:79], v14 offset:4096
    ds_read_b128 v[80:83], v15 offset:4096
    ds_read_b128 v[68:71], v12 offset:4096
    ds_read_b128 v[72:75], v13 offset:4096
    ds_read_b128 v[52:55], v5 offset:64
    ds_read_b128 v[56:59], v5 offset:96
    v_mfma_f32_32x32x16_bf16 v[112:127], v[60:63], v[84:87], v[112:127]
    v_exp_f32 v128, v128
    v_exp_f32 v129, v129
    v_exp_f32 v130, v130
    v_exp_f32 v131, v131
    v_mfma_f32_32x32x16_bf16 v[112:127], v[64:67], v[88:91], v[112:127]
    v_exp_f32 v132, v132
    v_exp_f32 v133, v133
    v_exp_f32 v134, v134
    v_exp_f32 v135, v135
    ds_write_b16 v6, v10
    ds_read_b128 v[60:63], v9
    ds_read_b128 v[64:67], v9 offset:32
    ds_write_b16 v6, v11
    v_mfma_f32_32x32x16_bf16 v[160:175], v[32:35], v[40:43], 0
    v_exp_f32 v136, v136
    v_exp_f32 v137, v137
    v_exp_f32 v138, v138
    v_exp_f32 v139, v139
    s_waitcnt lgkmcnt(9)
    v_mfma_f32_32x32x16_bf16 v[176:191], v[76:79], v[44:47], 0
    v_exp_f32 v140, v140
    v_exp_f32 v141, v141
    v_exp_f32 v142, v142
    v_exp_f32 v143, v143
    s_waitcnt lgkmcnt(6)
    s_add_u32 m0, s37, 4096
    s_setprio 1
    v_pk_fma_f32 v[128:129], v[128:129], v[144:145], v[144:145]
    v_pk_fma_f32 v[130:131], v[130:131], v[146:147], v[146:147]
    v_pk_fma_f32 v[132:133], v[132:133], v[148:149], v[148:149]
    v_pk_fma_f32 v[134:135], v[134:135], v[150:151], v[150:151]
    v_pk_fma_f32 v[136:137], v[136:137], v[152:153], v[152:153]
    v_pk_fma_f32 v[138:139], v[138:139], v[154:155], v[154:155]
    v_pk_fma_f32 v[140:141], v[140:141], v[156:157], v[156:157]
    v_pk_fma_f32 v[142:143], v[142:143], v[158:159], v[158:159]
    v_mfma_f32_32x32x16_bf16 v[176:191], v[80:83], v[48:51], v[176:191]
    v_rcp_f32 v128, v128
    v_rcp_f32 v129, v129
    buffer_load_dwordx4 v[16:17], s[12:15], s46 idxen offen lds
    v_rcp_f32 v130, v130
    v_rcp_f32 v131, v131
    s_waitcnt lgkmcnt(5)
    v_mfma_f32_32x32x16_bf16 v[160:175], v[52:55], v[44:47], v[160:175]
    v_rcp_f32 v132, v132
    v_rcp_f32 v133, v133
    s_add_u32 m0, s37, 5120
    v_rcp_f32 v134, v134
    v_rcp_f32 v135, v135
    buffer_load_dwordx4 v[18:19], s[12:15], s46 idxen offen lds
    s_waitcnt lgkmcnt(4)
    v_mfma_f32_32x32x16_bf16 v[160:175], v[56:59], v[48:51], v[160:175]
    v_rcp_f32 v136, v136
    v_rcp_f32 v137, v137
    v_rcp_f32 v138, v138
    v_rcp_f32 v139, v139
    s_add_u32 m0, s37, 6144
    v_mfma_f32_32x32x16_bf16 v[160:175], v[68:71], v[44:47], v[160:175]
    v_rcp_f32 v140, v140
    v_rcp_f32 v141, v141
    buffer_load_dwordx4 v[20:21], s[12:15], s46 idxen offen lds
    v_rcp_f32 v142, v142
    v_rcp_f32 v143, v143
    v_mfma_f32_32x32x16_bf16 v[160:175], v[72:75], v[48:51], v[160:175]
    v_cvt_pk_bf16_f32 v84, v128, v129
    v_cvt_pk_bf16_f32 v85, v130, v131
    s_add_u32 m0, s37, 7168
    v_cvt_pk_bf16_f32 v86, v132, v133
    v_cvt_pk_bf16_f32 v87, v134, v135
    buffer_load_dwordx4 v[22:23], s[12:15], s46 idxen offen lds
    v_cvt_pk_bf16_f32 v88, v136, v137
    buffer_load_dwordx4 v[32:35], v[24:25], s[20:23], 0 idxen offen
    ds_read_u16 v16, v1 offset:0
    ds_read_u16 v18, v1 offset:16
    ds_read_u16 v20, v1 offset:32
    ds_read_u16 v22, v1 offset:48
    v_cvt_pk_bf16_f32 v89, v138, v139
    v_cvt_pk_bf16_f32 v90, v140, v141
    v_cvt_pk_bf16_f32 v91, v142, v143
    v_add_u32 v1, 64, v1
    v_and_b32 v4, 0xfff, v4
    v_add_u32 v5, v4, v7
    v_add_u32 v6, v4, v8
    s_setprio 0
    s_waitcnt vmcnt(5) lgkmcnt(0)
    ds_read_b128 v[76:79], v14 offset:0
    ds_read_b128 v[80:83], v15 offset:0
    ds_read_b128 v[68:71], v12 offset:0
    ds_read_b128 v[72:75], v13 offset:0
    ds_read_b128 v[52:55], v5 offset:0
    ds_read_b128 v[56:59], v5 offset:32
    v_mfma_f32_32x32x16_bf16 v[96:111], v[60:63], v[84:87], v[96:111]
    v_exp_f32 v160, v160
    v_exp_f32 v161, v161
    v_exp_f32 v162, v162
    v_exp_f32 v163, v163
    v_mfma_f32_32x32x16_bf16 v[96:111], v[64:67], v[88:91], v[96:111]
    v_exp_f32 v164, v164
    v_exp_f32 v165, v165
    v_exp_f32 v166, v166
    v_exp_f32 v167, v167
    v_mfma_f32_32x32x16_bf16 v[128:143], v[28:31], v[36:39], 0
    v_exp_f32 v168, v168
    v_exp_f32 v169, v169
    v_exp_f32 v170, v170
    v_exp_f32 v171, v171
    s_waitcnt lgkmcnt(5)
    v_mfma_f32_32x32x16_bf16 v[144:159], v[76:79], v[44:47], 0
    v_exp_f32 v172, v172
    v_exp_f32 v173, v173
    v_exp_f32 v174, v174
    v_exp_f32 v175, v175
    s_waitcnt lgkmcnt(2)
    s_add_u32 m0, s37, 0
    s_setprio 1
    v_pk_fma_f32 v[160:161], v[160:161], v[176:177], v[176:177]
    v_pk_fma_f32 v[162:163], v[162:163], v[178:179], v[178:179]
    v_pk_fma_f32 v[164:165], v[164:165], v[180:181], v[180:181]
    v_pk_fma_f32 v[166:167], v[166:167], v[182:183], v[182:183]
    v_pk_fma_f32 v[168:169], v[168:169], v[184:185], v[184:185]
    v_pk_fma_f32 v[170:171], v[170:171], v[186:187], v[186:187]
    v_pk_fma_f32 v[172:173], v[172:173], v[188:189], v[188:189]
    v_pk_fma_f32 v[174:175], v[174:175], v[190:191], v[190:191]
    v_mfma_f32_32x32x16_bf16 v[144:159], v[80:83], v[48:51], v[144:159]
    v_rcp_f32 v160, v160
    v_rcp_f32 v161, v161
    buffer_load_dwordx4 v[16:17], s[12:15], 0 idxen offen lds
    v_rcp_f32 v162, v162
    v_rcp_f32 v163, v163
    s_waitcnt lgkmcnt(1)
    v_mfma_f32_32x32x16_bf16 v[128:143], v[52:55], v[44:47], v[128:143]
    v_rcp_f32 v164, v164
    v_rcp_f32 v165, v165
    s_add_u32 m0, s37, 1024
    v_rcp_f32 v166, v166
    v_rcp_f32 v167, v167
    buffer_load_dwordx4 v[18:19], s[12:15], 0 idxen offen lds
    s_waitcnt lgkmcnt(0)
    v_mfma_f32_32x32x16_bf16 v[128:143], v[56:59], v[48:51], v[128:143]
    v_rcp_f32 v168, v168
    v_rcp_f32 v169, v169
    ds_read_b32 v24, v2
    ds_read_u16 v4, v3
    v_rcp_f32 v170, v170
    v_rcp_f32 v171, v171
    s_add_u32 m0, s37, 2048
    v_mfma_f32_32x32x16_bf16 v[128:143], v[68:71], v[44:47], v[128:143]
    v_rcp_f32 v172, v172
    v_rcp_f32 v173, v173
    buffer_load_dwordx4 v[20:21], s[12:15], 0 idxen offen lds
    v_rcp_f32 v174, v174
    v_rcp_f32 v175, v175
    v_mfma_f32_32x32x16_bf16 v[128:143], v[72:75], v[48:51], v[128:143]
    v_cvt_pk_bf16_f32 v84, v160, v161
    v_cvt_pk_bf16_f32 v85, v162, v163
    s_add_u32 m0, s37, 3072
    v_cvt_pk_bf16_f32 v86, v164, v165
    v_cvt_pk_bf16_f32 v87, v166, v167
    buffer_load_dwordx4 v[22:23], s[12:15], 0 idxen offen lds
    v_cvt_pk_bf16_f32 v88, v168, v169
    v_cvt_pk_bf16_f32 v89, v170, v171
    v_cvt_pk_bf16_f32 v90, v172, v173
    v_cvt_pk_bf16_f32 v91, v174, v175
    v_add_u32 v2, 128, v2
    v_add_u32 v3, 64, v3
    s_sub_i32 s36, s36, 32
    s_branch L_k2_main
L_k2_tile:
    s_cmp_gt_i32 s36, 32
    s_cbranch_scc0 L_k2_last0
    s_setprio 0
    s_waitcnt vmcnt(5) lgkmcnt(0)
    ds_read_b128 v[76:79], v14 offset:4096
    ds_read_b128 v[80:83], v15 offset:4096
    ds_read_b128 v[68:71], v12 offset:4096
    ds_read_b128 v[72:75], v13 offset:4096
    ds_read_b128 v[52:55], v5 offset:64
    ds_read_b128 v[56:59], v5 offset:96
    v_mfma_f32_32x32x16_bf16 v[112:127], v[60:63], v[84:87], v[112:127]
    v_exp_f32 v128, v128
    v_exp_f32 v129, v129
    v_exp_f32 v130, v130
    v_exp_f32 v131, v131
    v_mfma_f32_32x32x16_bf16 v[112:127], v[64:67], v[88:91], v[112:127]
    v_exp_f32 v132, v132
    v_exp_f32 v133, v133
    v_exp_f32 v134, v134
    v_exp_f32 v135, v135
    ds_write_b16 v6, v10
    ds_read_b128 v[60:63], v9
    ds_read_b128 v[64:67], v9 offset:32
    ds_write_b16 v6, v11
    v_mfma_f32_32x32x16_bf16 v[160:175], v[28:31], v[40:43], 0
    v_exp_f32 v136, v136
    v_exp_f32 v137, v137
    v_exp_f32 v138, v138
    v_exp_f32 v139, v139
    s_waitcnt lgkmcnt(9)
    v_mfma_f32_32x32x16_bf16 v[176:191], v[76:79], v[44:47], 0
    v_exp_f32 v140, v140
    v_exp_f32 v141, v141
    v_exp_f32 v142, v142
    v_exp_f32 v143, v143
    s_waitcnt lgkmcnt(6)
    s_add_u32 m0, s37, 4096
    s_setprio 1
    v_pk_fma_f32 v[128:129], v[128:129], v[144:145], v[144:145]
    v_pk_fma_f32 v[130:131], v[130:131], v[146:147], v[146:147]
    v_pk_fma_f32 v[132:133], v[132:133], v[148:149], v[148:149]
    v_pk_fma_f32 v[134:135], v[134:135], v[150:151], v[150:151]
    v_pk_fma_f32 v[136:137], v[136:137], v[152:153], v[152:153]
    v_pk_fma_f32 v[138:139], v[138:139], v[154:155], v[154:155]
    v_pk_fma_f32 v[140:141], v[140:141], v[156:157], v[156:157]
    v_pk_fma_f32 v[142:143], v[142:143], v[158:159], v[158:159]
    v_mfma_f32_32x32x16_bf16 v[176:191], v[80:83], v[48:51], v[176:191]
    v_rcp_f32 v128, v128
    v_rcp_f32 v129, v129
    buffer_load_dwordx4 v[16:17], s[12:15], s46 idxen offen lds
    v_rcp_f32 v130, v130
    v_rcp_f32 v131, v131
    s_waitcnt lgkmcnt(5)
    v_mfma_f32_32x32x16_bf16 v[160:175], v[52:55], v[44:47], v[160:175]
    v_rcp_f32 v132, v132
    v_rcp_f32 v133, v133
    s_add_u32 m0, s37, 5120
    v_rcp_f32 v134, v134
    v_rcp_f32 v135, v135
    buffer_load_dwordx4 v[18:19], s[12:15], s46 idxen offen lds
    s_waitcnt lgkmcnt(4)
    v_mfma_f32_32x32x16_bf16 v[160:175], v[56:59], v[48:51], v[160:175]
    v_rcp_f32 v136, v136
    v_rcp_f32 v137, v137
    v_rcp_f32 v138, v138
    v_rcp_f32 v139, v139
    s_add_u32 m0, s37, 6144
    v_mfma_f32_32x32x16_bf16 v[160:175], v[68:71], v[44:47], v[160:175]
    v_rcp_f32 v140, v140
    v_rcp_f32 v141, v141
    buffer_load_dwordx4 v[20:21], s[12:15], s46 idxen offen lds
    s_cmp_gt_i32 s36, 64
    s_cselect_b32 s22, 160000, 0
    v_rcp_f32 v142, v142
    v_rcp_f32 v143, v143
    v_mfma_f32_32x32x16_bf16 v[160:175], v[72:75], v[48:51], v[160:175]
    v_cvt_pk_bf16_f32 v84, v128, v129
    v_cvt_pk_bf16_f32 v85, v130, v131
    s_add_u32 m0, s37, 7168
    v_cvt_pk_bf16_f32 v86, v132, v133
    v_cvt_pk_bf16_f32 v87, v134, v135
    buffer_load_dwordx4 v[22:23], s[12:15], s46 idxen offen lds
    v_cvt_pk_bf16_f32 v88, v136, v137
    buffer_load_dwordx4 v[28:31], v[24:25], s[20:23], 0 idxen offen
    ds_read_u16 v16, v1 offset:0
    ds_read_u16 v18, v1 offset:16
    ds_read_u16 v20, v1 offset:32
    ds_read_u16 v22, v1 offset:48
    v_cvt_pk_bf16_f32 v89, v138, v139
    v_cvt_pk_bf16_f32 v90, v140, v141
    v_cvt_pk_bf16_f32 v91, v142, v143
    v_add_u32 v1, 64, v1
    v_and_b32 v4, 0xfff, v4
    v_add_u32 v5, v4, v7
    v_add_u32 v6, v4, v8
    s_setprio 0
    s_waitcnt vmcnt(5) lgkmcnt(0)
    ds_read_b128 v[76:79], v14 offset:0
    ds_read_b128 v[80:83], v15 offset:0
    ds_read_b128 v[68:71], v12 offset:0
    ds_read_b128 v[72:75], v13 offset:0
    ds_read_b128 v[52:55], v5 offset:0
    ds_read_b128 v[56:59], v5 offset:32
    v_mfma_f32_32x32x16_bf16 v[96:111], v[60:63], v[84:87], v[96:111]
    v_exp_f32 v160, v160
    v_exp_f32 v161, v161
    v_exp_f32 v162, v162
    v_exp_f32 v163, v163
    v_mfma_f32_32x32x16_bf16 v[96:111], v[64:67], v[88:91], v[96:111]
    v_exp_f32 v164, v164
    v_exp_f32 v165, v165
    v_exp_f32 v166, v166
    v_exp_f32 v167, v167
    v_mfma_f32_32x32x16_bf16 v[128:143], v[32:35], v[36:39], 0
    v_exp_f32 v168, v168
    v_exp_f32 v169, v169
    v_exp_f32 v170, v170
    v_exp_f32 v171, v171
    s_waitcnt lgkmcnt(5)
    v_mfma_f32_32x32x16_bf16 v[144:159], v[76:79], v[44:47], 0
    v_exp_f32 v172, v172
    v_exp_f32 v173, v173
    v_exp_f32 v174, v174
    s_cmp_gt_i32 s36, 64
    s_cselect_b32 s14, 10000, 0
    v_exp_f32 v175, v175
    s_waitcnt lgkmcnt(2)
    s_add_u32 m0, s37, 0
    s_setprio 1
    v_pk_fma_f32 v[160:161], v[160:161], v[176:177], v[176:177]
    v_pk_fma_f32 v[162:163], v[162:163], v[178:179], v[178:179]
    v_pk_fma_f32 v[164:165], v[164:165], v[180:181], v[180:181]
    v_pk_fma_f32 v[166:167], v[166:167], v[182:183], v[182:183]
    v_pk_fma_f32 v[168:169], v[168:169], v[184:185], v[184:185]
    v_pk_fma_f32 v[170:171], v[170:171], v[186:187], v[186:187]
    v_pk_fma_f32 v[172:173], v[172:173], v[188:189], v[188:189]
    v_pk_fma_f32 v[174:175], v[174:175], v[190:191], v[190:191]
    v_mfma_f32_32x32x16_bf16 v[144:159], v[80:83], v[48:51], v[144:159]
    v_rcp_f32 v160, v160
    v_rcp_f32 v161, v161
    buffer_load_dwordx4 v[16:17], s[12:15], 0 idxen offen lds
    v_rcp_f32 v162, v162
    v_rcp_f32 v163, v163
    s_waitcnt lgkmcnt(1)
    v_mfma_f32_32x32x16_bf16 v[128:143], v[52:55], v[44:47], v[128:143]
    v_rcp_f32 v164, v164
    v_rcp_f32 v165, v165
    s_add_u32 m0, s37, 1024
    v_rcp_f32 v166, v166
    v_rcp_f32 v167, v167
    buffer_load_dwordx4 v[18:19], s[12:15], 0 idxen offen lds
    s_waitcnt lgkmcnt(0)
    v_mfma_f32_32x32x16_bf16 v[128:143], v[56:59], v[48:51], v[128:143]
    v_rcp_f32 v168, v168
    v_rcp_f32 v169, v169
    ds_read_b32 v24, v2
    ds_read_u16 v4, v3
    v_rcp_f32 v170, v170
    v_rcp_f32 v171, v171
    s_add_u32 m0, s37, 2048
    v_mfma_f32_32x32x16_bf16 v[128:143], v[68:71], v[44:47], v[128:143]
    v_rcp_f32 v172, v172
    v_rcp_f32 v173, v173
    buffer_load_dwordx4 v[20:21], s[12:15], 0 idxen offen lds
    v_rcp_f32 v174, v174
    v_rcp_f32 v175, v175
    v_mfma_f32_32x32x16_bf16 v[128:143], v[72:75], v[48:51], v[128:143]
    v_cvt_pk_bf16_f32 v84, v160, v161
    v_cvt_pk_bf16_f32 v85, v162, v163
    s_add_u32 m0, s37, 3072
    v_cvt_pk_bf16_f32 v86, v164, v165
    v_cvt_pk_bf16_f32 v87, v166, v167
    buffer_load_dwordx4 v[22:23], s[12:15], 0 idxen offen lds
    v_cvt_pk_bf16_f32 v88, v168, v169
    v_cvt_pk_bf16_f32 v89, v170, v171
    v_cvt_pk_bf16_f32 v90, v172, v173
    v_cvt_pk_bf16_f32 v91, v174, v175
    v_add_u32 v2, 128, v2
    v_add_u32 v3, 64, v3
    s_sub_i32 s36, s36, 32
    s_cmp_gt_i32 s36, 32
    s_cbranch_scc0 L_k2_last1
    s_setprio 0
    s_waitcnt vmcnt(5) lgkmcnt(0)
    ds_read_b128 v[76:79], v14 offset:4096
    ds_read_b128 v[80:83], v15 offset:4096
    ds_read_b128 v[68:71], v12 offset:4096
    ds_read_b128 v[72:75], v13 offset:4096
    ds_read_b128 v[52:55], v5 offset:64
    ds_read_b128 v[56:59], v5 offset:96
    v_mfma_f32_32x32x16_bf16 v[112:127], v[60:63], v[84:87], v[112:127]
    v_exp_f32 v128, v128
    v_exp_f32 v129, v129
    v_exp_f32 v130, v130
    v_exp_f32 v131, v131
    v_mfma_f32_32x32x16_bf16 v[112:127], v[64:67], v[88:91], v[112:127]
    v_exp_f32 v132, v132
    v_exp_f32 v133, v133
    v_exp_f32 v134, v134
    v_exp_f32 v135, v135
    ds_write_b16 v6, v10
    ds_read_b128 v[60:63], v9
    ds_read_b128 v[64:67], v9 offset:32
    ds_write_b16 v6, v11
    v_mfma_f32_32x32x16_bf16 v[160:175], v[32:35], v[40:43], 0
    v_exp_f32 v136, v136
    v_exp_f32 v137, v137
    v_exp_f32 v138, v138
    v_exp_f32 v139, v139
    s_waitcnt lgkmcnt(9)
    v_mfma_f32_32x32x16_bf16 v[176:191], v[76:79], v[44:47], 0
    v_exp_f32 v140, v140
    v_exp_f32 v141, v141
    v_exp_f32 v142, v142
    v_exp_f32 v143, v143
    s_waitcnt lgkmcnt(6)
    s_add_u32 m0, s37, 4096
    s_setprio 1
    v_pk_fma_f32 v[128:129], v[128:129], v[144:145], v[144:145]
    v_pk_fma_f32 v[130:131], v[130:131], v[146:147], v[146:147]
    v_pk_fma_f32 v[132:133], v[132:133], v[148:149], v[148:149]
    v_pk_fma_f32 v[134:135], v[134:135], v[150:151], v[150:151]
    v_pk_fma_f32 v[136:137], v[136:137], v[152:153], v[152:153]
    v_pk_fma_f32 v[138:139], v[138:139], v[154:155], v[154:155]
    v_pk_fma_f32 v[140:141], v[140:141], v[156:157], v[156:157]
    v_pk_fma_f32 v[142:143], v[142:143], v[158:159], v[158:159]
    v_mfma_f32_32x32x16_bf16 v[176:191], v[80:83], v[48:51], v[176:191]
    v_rcp_f32 v128, v128
    v_rcp_f32 v129, v129
    buffer_load_dwordx4 v[16:17], s[12:15], s46 idxen offen lds
    v_rcp_f32 v130, v130
    v_rcp_f32 v131, v131
    s_waitcnt lgkmcnt(5)
    v_mfma_f32_32x32x16_bf16 v[160:175], v[52:55], v[44:47], v[160:175]
    v_rcp_f32 v132, v132
    v_rcp_f32 v133, v133
    s_add_u32 m0, s37, 5120
    v_rcp_f32 v134, v134
    v_rcp_f32 v135, v135
    buffer_load_dwordx4 v[18:19], s[12:15], s46 idxen offen lds
    s_waitcnt lgkmcnt(4)
    v_mfma_f32_32x32x16_bf16 v[160:175], v[56:59], v[48:51], v[160:175]
    v_rcp_f32 v136, v136
    v_rcp_f32 v137, v137
    v_rcp_f32 v138, v138
    v_rcp_f32 v139, v139
    s_add_u32 m0, s37, 6144
    v_mfma_f32_32x32x16_bf16 v[160:175], v[68:71], v[44:47], v[160:175]
    v_rcp_f32 v140, v140
    v_rcp_f32 v141, v141
    buffer_load_dwordx4 v[20:21], s[12:15], s46 idxen offen lds
    s_cmp_gt_i32 s36, 64
    s_cselect_b32 s22, 160000, 0
    v_rcp_f32 v142, v142
    v_rcp_f32 v143, v143
    v_mfma_f32_32x32x16_bf16 v[160:175], v[72:75], v[48:51], v[160:175]
    v_cvt_pk_bf16_f32 v84, v128, v129
    v_cvt_pk_bf16_f32 v85, v130, v131
    s_add_u32 m0, s37, 7168
    v_cvt_pk_bf16_f32 v86, v132, v133
    v_cvt_pk_bf16_f32 v87, v134, v135
    buffer_load_dwordx4 v[22:23], s[12:15], s46 idxen offen lds
    v_cvt_pk_bf16_f32 v88, v136, v137
    buffer_load_dwordx4 v[32:35], v[24:25], s[20:23], 0 idxen offen
    ds_read_u16 v16, v1 offset:0
    ds_read_u16 v18, v1 offset:16
    ds_read_u16 v20, v1 offset:32
    ds_read_u16 v22, v1 offset:48
    v_cvt_pk_bf16_f32 v89, v138, v139
    v_cvt_pk_bf16_f32 v90, v140, v141
    v_cvt_pk_bf16_f32 v91, v142, v143
    v_add_u32 v1, 64, v1
    v_and_b32 v4, 0xfff, v4
    v_add_u32 v5, v4, v7
    v_add_u32 v6, v4, v8
    s_setprio 0
    s_waitcnt vmcnt(5) lgkmcnt(0)
    ds_read_b128 v[76:79], v14 offset:0
    ds_read_b128 v[80:83], v15 offset:0
    ds_read_b128 v[68:71], v12 offset:0
    ds_read_b128 v[72:75], v13 offset:0
    ds_read_b128 v[52:55], v5 offset:0
    ds_read_b128 v[56:59], v5 offset:32
    v_mfma_f32_32x32x16_bf16 v[96:111], v[60:63], v[84:87], v[96:111]
    v_exp_f32 v160, v160
    v_exp_f32 v161, v161
    v_exp_f32 v162, v162
    v_exp_f32 v163, v163
    v_mfma_f32_32x32x16_bf16 v[96:111], v[64:67], v[88:91], v[96:111]
    v_exp_f32 v164, v164
    v_exp_f32 v165, v165
    v_exp_f32 v166, v166
    v_exp_f32 v167, v167
    v_mfma_f32_32x32x16_bf16 v[128:143], v[28:31], v[36:39], 0
    v_exp_f32 v168, v168
    v_exp_f32 v169, v169
    v_exp_f32 v170, v170
    v_exp_f32 v171, v171
    s_waitcnt lgkmcnt(5)
    v_mfma_f32_32x32x16_bf16 v[144:159], v[76:79], v[44:47], 0
    v_exp_f32 v172, v172
    v_exp_f32 v173, v173
    v_exp_f32 v174, v174
    s_cmp_gt_i32 s36, 64
    s_cselect_b32 s14, 10000, 0
    v_exp_f32 v175, v175
    s_waitcnt lgkmcnt(2)
    s_add_u32 m0, s37, 0
    s_setprio 1
    v_pk_fma_f32 v[160:161], v[160:161], v[176:177], v[176:177]
    v_pk_fma_f32 v[162:163], v[162:163], v[178:179], v[178:179]
    v_pk_fma_f32 v[164:165], v[164:165], v[180:181], v[180:181]
    v_pk_fma_f32 v[166:167], v[166:167], v[182:183], v[182:183]
    v_pk_fma_f32 v[168:169], v[168:169], v[184:185], v[184:185]
    v_pk_fma_f32 v[170:171], v[170:171], v[186:187], v[186:187]
    v_pk_fma_f32 v[172:173], v[172:173], v[188:189], v[188:189]
    v_pk_fma_f32 v[174:175], v[174:175], v[190:191], v[190:191]
    v_mfma_f32_32x32x16_bf16 v[144:159], v[80:83], v[48:51], v[144:159]
    v_rcp_f32 v160, v160
    v_rcp_f32 v161, v161
    buffer_load_dwordx4 v[16:17], s[12:15], 0 idxen offen lds
    v_rcp_f32 v162, v162
    v_rcp_f32 v163, v163
    s_waitcnt lgkmcnt(1)
    v_mfma_f32_32x32x16_bf16 v[128:143], v[52:55], v[44:47], v[128:143]
    v_rcp_f32 v164, v164
    v_rcp_f32 v165, v165
    s_add_u32 m0, s37, 1024
    v_rcp_f32 v166, v166
    v_rcp_f32 v167, v167
    buffer_load_dwordx4 v[18:19], s[12:15], 0 idxen offen lds
    s_waitcnt lgkmcnt(0)
    v_mfma_f32_32x32x16_bf16 v[128:143], v[56:59], v[48:51], v[128:143]
    v_rcp_f32 v168, v168
    v_rcp_f32 v169, v169
    ds_read_b32 v24, v2
    ds_read_u16 v4, v3
    v_rcp_f32 v170, v170
    v_rcp_f32 v171, v171
    s_add_u32 m0, s37, 2048
    v_mfma_f32_32x32x16_bf16 v[128:143], v[68:71], v[44:47], v[128:143]
    v_rcp_f32 v172, v172
    v_rcp_f32 v173, v173
    buffer_load_dwordx4 v[20:21], s[12:15], 0 idxen offen lds
    v_rcp_f32 v174, v174
    v_rcp_f32 v175, v175
    v_mfma_f32_32x32x16_bf16 v[128:143], v[72:75], v[48:51], v[128:143]
    v_cvt_pk_bf16_f32 v84, v160, v161
    v_cvt_pk_bf16_f32 v85, v162, v163
    s_add_u32 m0, s37, 3072
    v_cvt_pk_bf16_f32 v86, v164, v165
    v_cvt_pk_bf16_f32 v87, v166, v167
    buffer_load_dwordx4 v[22:23], s[12:15], 0 idxen offen lds
    v_cvt_pk_bf16_f32 v88, v168, v169
    v_cvt_pk_bf16_f32 v89, v170, v171
    v_cvt_pk_bf16_f32 v90, v172, v173
    v_cvt_pk_bf16_f32 v91, v174, v175
    v_add_u32 v2, 128, v2
    v_add_u32 v3, 64, v3
    s_sub_i32 s36, s36, 32
    s_branch L_k2_tile
L_k2_last0:
    s_cmp_gt_i32 s36, 16
    s_cbranch_scc0 L_k2_lasth0
    s_setprio 0
    s_waitcnt vmcnt(5) lgkmcnt(0)
    ds_read_b128 v[76:79], v14 offset:4096
    ds_read_b128 v[80:83], v15 offset:4096
    ds_read_b128 v[68:71], v12 offset:4096
    ds_read_b128 v[72:75], v13 offset:4096
    ds_read_b128 v[52:55], v5 offset:64
    ds_read_b128 v[56:59], v5 offset:96
    v_mfma_f32_32x32x16_bf16 v[112:127], v[60:63], v[84:87], v[112:127]
    v_exp_f32 v128, v128
    v_exp_f32 v129, v129
    v_exp_f32 v130, v130
    v_exp_f32 v131, v131
    v_mfma_f32_32x32x16_bf16 v[112:127], v[64:67], v[88:91], v[112:127]
    v_exp_f32 v132, v132
    v_exp_f32 v133, v133
    v_exp_f32 v134, v134
    v_exp_f32 v135, v135
    s_bfm_b32 s40, s36, 0
    s_cmp_ge_u32 s36, 32
    s_cselect_b32 exec_lo, -1, s40
    s_mov_b32 exec_hi, 0
    ds_write_b16 v6, v10
    s_mov_b64 exec, -1
    ds_read_b128 v[60:63], v9
    ds_read_b128 v[64:67], v9 offset:32
    ds_write_b16 v6, v11
    v_mfma_f32_32x32x16_bf16 v[160:175], v[28:31], v[40:43], 0
    v_exp_f32 v136, v136
    v_exp_f32 v137, v137
    v_exp_f32 v138, v138
    v_exp_f32 v139, v139
    s_waitcnt lgkmcnt(9)
    v_mfma_f32_32x32x16_bf16 v[176:191], v[76:79], v[44:47], 0
    v_exp_f32 v140, v140
    v_exp_f32 v141, v141
    v_exp_f32 v142, v142
    v_exp_f32 v143, v143
    s_setprio 1
    v_pk_fma_f32 v[128:129], v[128:129], v[144:145], v[144:145]
    v_pk_fma_f32 v[130:131], v[130:131], v[146:147], v[146:147]
    v_pk_fma_f32 v[132:133], v[132:133], v[148:149], v[148:149]
    v_pk_fma_f32 v[134:135], v[134:135], v[150:151], v[150:151]
    v_pk_fma_f32 v[136:137], v[136:137], v[152:153], v[152:153]
    v_pk_fma_f32 v[138:139], v[138:139], v[154:155], v[154:155]
    v_pk_fma_f32 v[140:141], v[140:141], v[156:157], v[156:157]
    v_pk_fma_f32 v[142:143], v[142:143], v[158:159], v[158:159]
    s_waitcnt lgkmcnt(8)
    v_mfma_f32_32x32x16_bf16 v[176:191], v[80:83], v[48:51], v[176:191]
    v_rcp_f32 v128, v128
    v_rcp_f32 v129, v129
    v_rcp_f32 v130, v130
    v_rcp_f32 v131, v131
    s_waitcnt lgkmcnt(5)
    v_mfma_f32_32x32x16_bf16 v[160:175], v[52:55], v[44:47], v[160:175]
    v_rcp_f32 v132, v132
    v_rcp_f32 v133, v133
    v_rcp_f32 v134, v134
    v_rcp_f32 v135, v135
    s_waitcnt lgkmcnt(4)
    v_mfma_f32_32x32x16_bf16 v[160:175], v[56:59], v[48:51], v[160:175]
    v_rcp_f32 v136, v136
    v_rcp_f32 v137, v137
    v_rcp_f32 v138, v138
    v_rcp_f32 v139, v139
    v_mfma_f32_32x32x16_bf16 v[160:175], v[68:71], v[44:47], v[160:175]
    v_rcp_f32 v140, v140
    v_rcp_f32 v141, v141
    v_rcp_f32 v142, v142
    v_rcp_f32 v143, v143
    v_mfma_f32_32x32x16_bf16 v[160:175], v[72:75], v[48:51], v[160:175]
    v_cvt_pk_bf16_f32 v84, v128, v129
    v_cvt_pk_bf16_f32 v85, v130, v131
    v_cvt_pk_bf16_f32 v86, v132, v133
    v_cvt_pk_bf16_f32 v87, v134, v135
    v_cvt_pk_bf16_f32 v88, v136, v137
    v_cvt_pk_bf16_f32 v89, v138, v139
    v_cvt_pk_bf16_f32 v90, v140, v141
    v_cvt_pk_bf16_f32 v91, v142, v143
    s_setprio 0
    s_waitcnt lgkmcnt(0)
    v_mfma_f32_32x32x16_bf16 v[96:111], v[60:63], v[84:87], v[96:111]
    v_exp_f32 v160, v160
    v_exp_f32 v161, v161
    v_exp_f32 v162, v162
    v_exp_f32 v163, v163
    v_mfma_f32_32x32x16_bf16 v[96:111], v[64:67], v[88:91], v[96:111]
    v_exp_f32 v164, v164
    v_exp_f32 v165, v165
    v_exp_f32 v166, v166
    v_exp_f32 v167, v167
    v_exp_f32 v168, v168
    v_exp_f32 v169, v169
    v_exp_f32 v170, v170
    v_exp_f32 v171, v171
    v_exp_f32 v172, v172
    v_exp_f32 v173, v173
    v_exp_f32 v174, v174
    v_exp_f32 v175, v175
    s_setprio 1
    v_pk_fma_f32 v[160:161], v[160:161], v[176:177], v[176:177]
    v_pk_fma_f32 v[162:163], v[162:163], v[178:179], v[178:179]
    v_pk_fma_f32 v[164:165], v[164:165], v[180:181], v[180:181]
    v_pk_fma_f32 v[166:167], v[166:167], v[182:183], v[182:183]
    v_pk_fma_f32 v[168:169], v[168:169], v[184:185], v[184:185]
    v_pk_fma_f32 v[170:171], v[170:171], v[186:187], v[186:187]
    v_pk_fma_f32 v[172:173], v[172:173], v[188:189], v[188:189]
    v_pk_fma_f32 v[174:175], v[174:175], v[190:191], v[190:191]
    v_rcp_f32 v160, v160
    v_rcp_f32 v161, v161
    v_rcp_f32 v162, v162
    v_rcp_f32 v163, v163
    v_rcp_f32 v164, v164
    v_rcp_f32 v165, v165
    v_rcp_f32 v166, v166
    v_rcp_f32 v167, v167
    v_rcp_f32 v168, v168
    v_rcp_f32 v169, v169
    v_rcp_f32 v170, v170
    v_rcp_f32 v171, v171
    v_rcp_f32 v172, v172
    v_rcp_f32 v173, v173
    v_rcp_f32 v174, v174
    v_rcp_f32 v175, v175
    v_cvt_pk_bf16_f32 v84, v160, v161
    v_cvt_pk_bf16_f32 v85, v162, v163
    v_cvt_pk_bf16_f32 v86, v164, v165
    v_cvt_pk_bf16_f32 v87, v166, v167
    v_cvt_pk_bf16_f32 v88, v168, v169
    v_cvt_pk_bf16_f32 v89, v170, v171
    v_cvt_pk_bf16_f32 v90, v172, v173
    v_cvt_pk_bf16_f32 v91, v174, v175
    s_nop 1
    v_mfma_f32_32x32x16_bf16 v[112:127], v[60:63], v[84:87], v[112:127]
    v_mfma_f32_32x32x16_bf16 v[112:127], v[64:67], v[88:91], v[112:127]
    s_branch L_k2_tiles_done
L_k2_lasth0:
    s_setprio 0
    s_waitcnt vmcnt(5) lgkmcnt(0)
    ds_read_b128 v[76:79], v14 offset:4096
    ds_read_b128 v[80:83], v15 offset:4096
    ds_read_b128 v[68:71], v12 offset:4096
    ds_read_b128 v[72:75], v13 offset:4096
    ds_read_b128 v[52:55], v5 offset:64
    ds_read_b128 v[56:59], v5 offset:96
    v_mfma_f32_32x32x16_bf16 v[112:127], v[60:63], v[84:87], v[112:127]
    v_exp_f32 v128, v128
    v_exp_f32 v129, v129
    v_exp_f32 v130, v130
    v_exp_f32 v131, v131
    v_mfma_f32_32x32x16_bf16 v[112:127], v[64:67], v[88:91], v[112:127]
    v_exp_f32 v132, v132
    v_exp_f32 v133, v133
    v_exp_f32 v134, v134
    v_exp_f32 v135, v135
    s_bfm_b32 s40, s36, 0
    s_cmp_ge_u32 s36, 32
    s_cselect_b32 exec_lo, -1, s40
    s_mov_b32 exec_hi, 0
    ds_write_b16 v6, v10
    s_mov_b64 exec, -1
    ds_read_b128 v[60:63], v9
    ds_read_b128 v[64:67], v9 offset:32
    ds_write_b16 v6, v11
    v_mfma_f32_32x32x16_bf16 v[160:175], v[28:31], v[40:43], 0
    s_waitcnt lgkmcnt(9)
    v_mfma_f32_32x32x16_bf16 v[176:191], v[76:79], v[44:47], 0
    s_nop 7
    s_setprio 1
    v_pk_fma_f32 v[128:129], v[128:129], v[144:145], v[144:145]
    v_pk_fma_f32 v[130:131], v[130:131], v[146:147], v[146:147]
    v_pk_fma_f32 v[132:133], v[132:133], v[148:149], v[148:149]
    v_pk_fma_f32 v[134:135], v[134:135], v[150:151], v[150:151]
    s_waitcnt lgkmcnt(8)
    v_mfma_f32_32x32x16_bf16 v[176:191], v[80:83], v[48:51], v[176:191]
    v_rcp_f32 v128, v128
    v_rcp_f32 v129, v129
    v_rcp_f32 v130, v130
    v_rcp_f32 v131, v131
    s_waitcnt lgkmcnt(5)
    v_mfma_f32_32x32x16_bf16 v[160:175], v[52:55], v[44:47], v[160:175]
    v_rcp_f32 v132, v132
    v_rcp_f32 v133, v133
    v_rcp_f32 v134, v134
    v_rcp_f32 v135, v135
    s_waitcnt lgkmcnt(4)
    v_mfma_f32_32x32x16_bf16 v[160:175], v[56:59], v[48:51], v[160:175]
    v_mfma_f32_32x32x16_bf16 v[160:175], v[68:71], v[44:47], v[160:175]
    v_mfma_f32_32x32x16_bf16 v[160:175], v[72:75], v[48:51], v[160:175]
    v_cvt_pk_bf16_f32 v84, v128, v129
    v_cvt_pk_bf16_f32 v85, v130, v131
    v_cvt_pk_bf16_f32 v86, v132, v133
    v_cvt_pk_bf16_f32 v87, v134, v135
    s_nop 7
    s_setprio 0
    s_waitcnt lgkmcnt(0)
    v_mfma_f32_32x32x16_bf16 v[96:111], v[60:63], v[84:87], v[96:111]
    v_exp_f32 v160, v160
    v_exp_f32 v161, v161
    v_exp_f32 v162, v162
    v_exp_f32 v163, v163
    v_exp_f32 v164, v164
    v_exp_f32 v165, v165
    v_exp_f32 v166, v166
    v_exp_f32 v167, v167
    s_setprio 1
    v_pk_fma_f32 v[160:161], v[160:161], v[176:177], v[176:177]
    v_pk_fma_f32 v[162:163], v[162:163], v[178:179], v[178:179]
    v_pk_fma_f32 v[164:165], v[164:165], v[180:181], v[180:181]
    v_pk_fma_f32 v[166:167], v[166:167], v[182:183], v[182:183]
    v_rcp_f32 v160, v160
    v_rcp_f32 v161, v161
    v_rcp_f32 v162, v162
    v_rcp_f32 v163, v163
    v_rcp_f32 v164, v164
    v_rcp_f32 v165, v165
    v_rcp_f32 v166, v166
    v_rcp_f32 v167, v167
    v_cvt_pk_bf16_f32 v84, v160, v161
    v_cvt_pk_bf16_f32 v85, v162, v163
    v_cvt_pk_bf16_f32 v86, v164, v165
    v_cvt_pk_bf16_f32 v87, v166, v167
    s_nop 1
    v_mfma_f32_32x32x16_bf16 v[112:127], v[60:63], v[84:87], v[112:127]
    s_branch L_k2_tiles_done
L_k2_last1:
    s_cmp_gt_i32 s36, 16
    s_cbranch_scc0 L_k2_lasth1
    s_setprio 0
    s_waitcnt vmcnt(5) lgkmcnt(0)
    ds_read_b128 v[76:79], v14 offset:4096
    ds_read_b128 v[80:83], v15 offset:4096
    ds_read_b128 v[68:71], v12 offset:4096
    ds_read_b128 v[72:75], v13 offset:4096
    ds_read_b128 v[52:55], v5 offset:64
    ds_read_b128 v[56:59], v5 offset:96
    v_mfma_f32_32x32x16_bf16 v[112:127], v[60:63], v[84:87], v[112:127]
    v_exp_f32 v128, v128
    v_exp_f32 v129, v129
    v_exp_f32 v130, v130
    v_exp_f32 v131, v131
    v_mfma_f32_32x32x16_bf16 v[112:127], v[64:67], v[88:91], v[112:127]
    v_exp_f32 v132, v132
    v_exp_f32 v133, v133
    v_exp_f32 v134, v134
    v_exp_f32 v135, v135
    s_bfm_b32 s40, s36, 0
    s_cmp_ge_u32 s36, 32
    s_cselect_b32 exec_lo, -1, s40
    s_mov_b32 exec_hi, 0
    ds_write_b16 v6, v10
    s_mov_b64 exec, -1
    ds_read_b128 v[60:63], v9
    ds_read_b128 v[64:67], v9 offset:32
    ds_write_b16 v6, v11
    v_mfma_f32_32x32x16_bf16 v[160:175], v[32:35], v[40:43], 0
    v_exp_f32 v136, v136
    v_exp_f32 v137, v137
    v_exp_f32 v138, v138
    v_exp_f32 v139, v139
    s_waitcnt lgkmcnt(9)
    v_mfma_f32_32x32x16_bf16 v[176:191], v[76:79], v[44:47], 0
    v_exp_f32 v140, v140
    v_exp_f32 v141, v141
    v_exp_f32 v142, v142
    v_exp_f32 v143, v143
    s_setprio 1
    v_pk_fma_f32 v[128:129], v[128:129], v[144:145], v[144:145]
    v_pk_fma_f32 v[130:131], v[130:131], v[146:147], v[146:147]
    v_pk_fma_f32 v[132:133], v[132:133], v[148:149], v[148:149]
    v_pk_fma_f32 v[134:135], v[134:135], v[150:151], v[150:151]
    v_pk_fma_f32 v[136:137], v[136:137], v[152:153], v[152:153]
    v_pk_fma_f32 v[138:139], v[138:139], v[154:155], v[154:155]
    v_pk_fma_f32 v[140:141], v[140:141], v[156:157], v[156:157]
    v_pk_fma_f32 v[142:143], v[142:143], v[158:159], v[158:159]
    s_waitcnt lgkmcnt(8)
    v_mfma_f32_32x32x16_bf16 v[176:191], v[80:83], v[48:51], v[176:191]
    v_rcp_f32 v128, v128
    v_rcp_f32 v129, v129
    v_rcp_f32 v130, v130
    v_rcp_f32 v131, v131
    s_waitcnt lgkmcnt(5)
    v_mfma_f32_32x32x16_bf16 v[160:175], v[52:55], v[44:47], v[160:175]
    v_rcp_f32 v132, v132
    v_rcp_f32 v133, v133
    v_rcp_f32 v134, v134
    v_rcp_f32 v135, v135
    s_waitcnt lgkmcnt(4)
    v_mfma_f32_32x32x16_bf16 v[160:175], v[56:59], v[48:51], v[160:175]
    v_rcp_f32 v136, v136
    v_rcp_f32 v137, v137
    v_rcp_f32 v138, v138
    v_rcp_f32 v139, v139
    v_mfma_f32_32x32x16_bf16 v[160:175], v[68:71], v[44:47], v[160:175]
    v_rcp_f32 v140, v140
    v_rcp_f32 v141, v141
    v_rcp_f32 v142, v142
    v_rcp_f32 v143, v143
    v_mfma_f32_32x32x16_bf16 v[160:175], v[72:75], v[48:51], v[160:175]
    v_cvt_pk_bf16_f32 v84, v128, v129
    v_cvt_pk_bf16_f32 v85, v130, v131
    v_cvt_pk_bf16_f32 v86, v132, v133
    v_cvt_pk_bf16_f32 v87, v134, v135
    v_cvt_pk_bf16_f32 v88, v136, v137
    v_cvt_pk_bf16_f32 v89, v138, v139
    v_cvt_pk_bf16_f32 v90, v140, v141
    v_cvt_pk_bf16_f32 v91, v142, v143
    s_setprio 0
    s_waitcnt lgkmcnt(0)
    v_mfma_f32_32x32x16_bf16 v[96:111], v[60:63], v[84:87], v[96:111]
    v_exp_f32 v160, v160
    v_exp_f32 v161, v161
    v_exp_f32 v162, v162
    v_exp_f32 v163, v163
    v_mfma_f32_32x32x16_bf16 v[96:111], v[64:67], v[88:91], v[96:111]
    v_exp_f32 v164, v164
    v_exp_f32 v165, v165
    v_exp_f32 v166, v166
    v_exp_f32 v167, v167
    v_exp_f32 v168, v168
    v_exp_f32 v169, v169
    v_exp_f32 v170, v170
    v_exp_f32 v171, v171
    v_exp_f32 v172, v172
    v_exp_f32 v173, v173
    v_exp_f32 v174, v174
    v_exp_f32 v175, v175
    s_setprio 1
    v_pk_fma_f32 v[160:161], v[160:161], v[176:177], v[176:177]
    v_pk_fma_f32 v[162:163], v[162:163], v[178:179], v[178:179]
    v_pk_fma_f32 v[164:165], v[164:165], v[180:181], v[180:181]
    v_pk_fma_f32 v[166:167], v[166:167], v[182:183], v[182:183]
    v_pk_fma_f32 v[168:169], v[168:169], v[184:185], v[184:185]
    v_pk_fma_f32 v[170:171], v[170:171], v[186:187], v[186:187]
    v_pk_fma_f32 v[172:173], v[172:173], v[188:189], v[188:189]
    v_pk_fma_f32 v[174:175], v[174:175], v[190:191], v[190:191]
    v_rcp_f32 v160, v160
    v_rcp_f32 v161, v161
    v_rcp_f32 v162, v162
    v_rcp_f32 v163, v163
    v_rcp_f32 v164, v164
    v_rcp_f32 v165, v165
    v_rcp_f32 v166, v166
    v_rcp_f32 v167, v167
    v_rcp_f32 v168, v168
    v_rcp_f32 v169, v169
    v_rcp_f32 v170, v170
    v_rcp_f32 v171, v171
    v_rcp_f32 v172, v172
    v_rcp_f32 v173, v173
    v_rcp_f32 v174, v174
    v_rcp_f32 v175, v175
    v_cvt_pk_bf16_f32 v84, v160, v161
    v_cvt_pk_bf16_f32 v85, v162, v163
    v_cvt_pk_bf16_f32 v86, v164, v165
    v_cvt_pk_bf16_f32 v87, v166, v167
    v_cvt_pk_bf16_f32 v88, v168, v169
    v_cvt_pk_bf16_f32 v89, v170, v171
    v_cvt_pk_bf16_f32 v90, v172, v173
    v_cvt_pk_bf16_f32 v91, v174, v175
    s_nop 1
    v_mfma_f32_32x32x16_bf16 v[112:127], v[60:63], v[84:87], v[112:127]
    v_mfma_f32_32x32x16_bf16 v[112:127], v[64:67], v[88:91], v[112:127]
    s_branch L_k2_tiles_done
L_k2_lasth1:
    s_setprio 0
    s_waitcnt vmcnt(5) lgkmcnt(0)
    ds_read_b128 v[76:79], v14 offset:4096
    ds_read_b128 v[80:83], v15 offset:4096
    ds_read_b128 v[68:71], v12 offset:4096
    ds_read_b128 v[72:75], v13 offset:4096
    ds_read_b128 v[52:55], v5 offset:64
    ds_read_b128 v[56:59], v5 offset:96
    v_mfma_f32_32x32x16_bf16 v[112:127], v[60:63], v[84:87], v[112:127]
    v_exp_f32 v128, v128
    v_exp_f32 v129, v129
    v_exp_f32 v130, v130
    v_exp_f32 v131, v131
    v_mfma_f32_32x32x16_bf16 v[112:127], v[64:67], v[88:91], v[112:127]
    v_exp_f32 v132, v132
    v_exp_f32 v133, v133
    v_exp_f32 v134, v134
    v_exp_f32 v135, v135
    s_bfm_b32 s40, s36, 0
    s_cmp_ge_u32 s36, 32
    s_cselect_b32 exec_lo, -1, s40
    s_mov_b32 exec_hi, 0
    ds_write_b16 v6, v10
    s_mov_b64 exec, -1
    ds_read_b128 v[60:63], v9
    ds_read_b128 v[64:67], v9 offset:32
    ds_write_b16 v6, v11
    v_mfma_f32_32x32x16_bf16 v[160:175], v[32:35], v[40:43], 0
    s_waitcnt lgkmcnt(9)
    v_mfma_f32_32x32x16_bf16 v[176:191], v[76:79], v[44:47], 0
    s_nop 7
    s_setprio 1
    v_pk_fma_f32 v[128:129], v[128:129], v[144:145], v[144:145]
    v_pk_fma_f32 v[130:131], v[130:131], v[146:147], v[146:147]
    v_pk_fma_f32 v[132:133], v[132:133], v[148:149], v[148:149]
    v_pk_fma_f32 v[134:135], v[134:135], v[150:151], v[150:151]
    s_waitcnt lgkmcnt(8)
    v_mfma_f32_32x32x16_bf16 v[176:191], v[80:83], v[48:51], v[176:191]
    v_rcp_f32 v128, v128
    v_rcp_f32 v129, v129
    v_rcp_f32 v130, v130
    v_rcp_f32 v131, v131
    s_waitcnt lgkmcnt(5)
    v_mfma_f32_32x32x16_bf16 v[160:175], v[52:55], v[44:47], v[160:175]
    v_rcp_f32 v132, v132
    v_rcp_f32 v133, v133
    v_rcp_f32 v134, v134
    v_rcp_f32 v135, v135
    s_waitcnt lgkmcnt(4)
    v_mfma_f32_32x32x16_bf16 v[160:175], v[56:59], v[48:51], v[160:175]
    v_mfma_f32_32x32x16_bf16 v[160:175], v[68:71], v[44:47], v[160:175]
    v_mfma_f32_32x32x16_bf16 v[160:175], v[72:75], v[48:51], v[160:175]
    v_cvt_pk_bf16_f32 v84, v128, v129
    v_cvt_pk_bf16_f32 v85, v130, v131
    v_cvt_pk_bf16_f32 v86, v132, v133
    v_cvt_pk_bf16_f32 v87, v134, v135
    s_nop 7
    s_setprio 0
    s_waitcnt lgkmcnt(0)
    v_mfma_f32_32x32x16_bf16 v[96:111], v[60:63], v[84:87], v[96:111]
    v_exp_f32 v160, v160
    v_exp_f32 v161, v161
    v_exp_f32 v162, v162
    v_exp_f32 v163, v163
    v_exp_f32 v164, v164
    v_exp_f32 v165, v165
    v_exp_f32 v166, v166
    v_exp_f32 v167, v167
    s_setprio 1
    v_pk_fma_f32 v[160:161], v[160:161], v[176:177], v[176:177]
    v_pk_fma_f32 v[162:163], v[162:163], v[178:179], v[178:179]
    v_pk_fma_f32 v[164:165], v[164:165], v[180:181], v[180:181]
    v_pk_fma_f32 v[166:167], v[166:167], v[182:183], v[182:183]
    v_rcp_f32 v160, v160
    v_rcp_f32 v161, v161
    v_rcp_f32 v162, v162
    v_rcp_f32 v163, v163
    v_rcp_f32 v164, v164
    v_rcp_f32 v165, v165
    v_rcp_f32 v166, v166
    v_rcp_f32 v167, v167
    v_cvt_pk_bf16_f32 v84, v160, v161
    v_cvt_pk_bf16_f32 v85, v162, v163
    v_cvt_pk_bf16_f32 v86, v164, v165
    v_cvt_pk_bf16_f32 v87, v166, v167
    s_nop 1
    v_mfma_f32_32x32x16_bf16 v[112:127], v[60:63], v[84:87], v[112:127]
    s_branch L_k2_tiles_done
L_k2_tiles_done:
    s_cmp_ge_u32 s33, 64
    s_cbranch_scc1 L_k2_epi
    s_waitcnt vmcnt(0) lgkmcnt(0)
    s_barrier
    s_mov_b32 s32, s33
    s_branch L_k2_round
L_k2_epi:
    s_mov_b32 s28, s38
    s_and_b32 s29, s39, 0xffff
    s_mov_b32 s30, 0x4e2000
    s_mov_b32 s31, 0x00020000
    s_waitcnt vmcnt(0)
    s_nop 7
    s_nop 7
    s_mov_b32 s40, 0xbfb8aa3b
    v_lshrrev_b32 v92, 5, v0
    v_lshlrev_b32 v92, 11, v92
    v_and_b32 v93, 31, v0
    v_lshl_add_u32 v92, v93, 1, v92
    v_mul_f32 v128, s40, v96
    v_mul_f32 v129, s40, v97
    v_mul_f32 v130, s40, v98
    v_mul_f32 v131, s40, v99
    v_mul_f32 v132, s40, v100
    v_mul_f32 v133, s40, v101
    v_mul_f32 v134, s40, v102
    v_mul_f32 v135, s40, v103
    v_mul_f32 v136, s40, v104
    v_mul_f32 v137, s40, v105
    v_mul_f32 v138, s40, v106
    v_mul_f32 v139, s40, v107
    v_exp_f32 v128, v128
    v_exp_f32 v129, v129
    v_exp_f32 v130, v130
    v_exp_f32 v131, v131
    v_exp_f32 v132, v132
    v_exp_f32 v133, v133
    v_exp_f32 v134, v134
    v_exp_f32 v135, v135
    v_exp_f32 v136, v136
    v_exp_f32 v137, v137
    v_exp_f32 v138, v138
    v_exp_f32 v139, v139
    v_add_f32 v128, 1.0, v128
    v_add_f32 v129, 1.0, v129
    v_add_f32 v130, 1.0, v130
    v_add_f32 v131, 1.0, v131
    v_add_f32 v132, 1.0, v132
    v_add_f32 v133, 1.0, v133
    v_add_f32 v134, 1.0, v134
    v_add_f32 v135, 1.0, v135
    v_add_f32 v136, 1.0, v136
    v_add_f32 v137, 1.0, v137
    v_add_f32 v138, 1.0, v138
    v_add_f32 v139, 1.0, v139
    v_rcp_f32 v128, v128
    v_rcp_f32 v129, v129
    v_rcp_f32 v130, v130
    v_rcp_f32 v131, v131
    v_rcp_f32 v132, v132
    v_rcp_f32 v133, v133
    v_rcp_f32 v134, v134
    v_rcp_f32 v135, v135
    v_rcp_f32 v136, v136
    v_rcp_f32 v137, v137
    v_rcp_f32 v138, v138
    v_rcp_f32 v139, v139
    s_nop 0
    v_mul_f32 v128, v128, v96
    v_mul_f32 v129, v129, v97
    v_mul_f32 v130, v130, v98
    v_mul_f32 v131, v131, v99
    v_mul_f32 v132, v132, v100
    v_mul_f32 v133, v133, v101
    v_mul_f32 v134, v134, v102
    v_mul_f32 v135, v135, v103
    v_mul_f32 v136, v136, v104
    v_mul_f32 v137, v137, v105
    v_mul_f32 v138, v138, v106
    v_mul_f32 v139, v139, v107
    v_cvt_pk_bf16_f32 v144, v128, v129
    v_cvt_pk_bf16_f32 v145, v130, v131
    v_cvt_pk_bf16_f32 v146, v132, v133
    v_cvt_pk_bf16_f32 v147, v134, v135
    v_cvt_pk_bf16_f32 v148, v136, v137
    v_cvt_pk_bf16_f32 v149, v138, v139
    v_mul_f32 v160, s40, v112
    v_mul_f32 v161, s40, v113
    v_mul_f32 v162, s40, v114
    v_mul_f32 v163, s40, v115
    v_mul_f32 v164, s40, v116
    v_mul_f32 v165, s40, v117
    v_mul_f32 v166, s40, v118
    v_mul_f32 v167, s40, v119
    v_mul_f32 v168, s40, v120
    v_mul_f32 v169, s40, v121
    v_mul_f32 v170, s40, v122
    v_mul_f32 v171, s40, v123
    v_exp_f32 v160, v160
    v_exp_f32 v161, v161
    v_exp_f32 v162, v162
    v_exp_f32 v163, v163
    v_exp_f32 v164, v164
    v_exp_f32 v165, v165
    v_exp_f32 v166, v166
    v_exp_f32 v167, v167
    v_exp_f32 v168, v168
    v_exp_f32 v169, v169
    v_exp_f32 v170, v170
    v_exp_f32 v171, v171
    v_add_f32 v160, 1.0, v160
    v_add_f32 v161, 1.0, v161
    v_add_f32 v162, 1.0, v162
    v_add_f32 v163, 1.0, v163
    v_add_f32 v164, 1.0, v164
    v_add_f32 v165, 1.0, v165
    v_add_f32 v166, 1.0, v166
    v_add_f32 v167, 1.0, v167
    v_add_f32 v168, 1.0, v168
    v_add_f32 v169, 1.0, v169
    v_add_f32 v170, 1.0, v170
    v_add_f32 v171, 1.0, v171
    v_rcp_f32 v160, v160
    v_rcp_f32 v161, v161
    v_rcp_f32 v162, v162
    v_rcp_f32 v163, v163
    v_rcp_f32 v164, v164
    v_rcp_f32 v165, v165
    v_rcp_f32 v166, v166
    v_rcp_f32 v167, v167
    v_rcp_f32 v168, v168
    v_rcp_f32 v169, v169
    v_rcp_f32 v170, v170
    v_rcp_f32 v171, v171
    s_nop 0
    v_mul_f32 v160, v160, v112
    v_mul_f32 v161, v161, v113
    v_mul_f32 v162, v162, v114
    v_mul_f32 v163, v163, v115
    v_mul_f32 v164, v164, v116
    v_mul_f32 v165, v165, v117
    v_mul_f32 v166, v166, v118
    v_mul_f32 v167, v167, v119
    v_mul_f32 v168, v168, v120
    v_mul_f32 v169, v169, v121
    v_mul_f32 v170, v170, v122
    v_mul_f32 v171, v171, v123
    v_cvt_pk_bf16_f32 v176, v160, v161
    v_cvt_pk_bf16_f32 v177, v162, v163
    v_cvt_pk_bf16_f32 v178, v164, v165
    v_cvt_pk_bf16_f32 v179, v166, v167
    v_cvt_pk_bf16_f32 v180, v168, v169
    v_cvt_pk_bf16_f32 v181, v170, v171
    v_lshrrev_b32 v92, 5, v0
    v_mul_u32_u24 v92, 576, v92
    v_and_b32 v93, 31, v0
    v_lshl_add_u32 v92, v93, 1, v92
    v_add_u32 v92, s37, v92
    ds_write_b16 v92, v144 offset:0
    ds_write_b16 v92, v176 offset:64
    ds_write_b16_d16_hi v92, v144 offset:144
    ds_write_b16_d16_hi v92, v176 offset:208
    ds_write_b16 v92, v145 offset:288
    ds_write_b16 v92, v177 offset:352
    ds_write_b16_d16_hi v92, v145 offset:432
    ds_write_b16_d16_hi v92, v177 offset:496
    ds_write_b16 v92, v146 offset:1152
    ds_write_b16 v92, v178 offset:1216
    ds_write_b16_d16_hi v92, v146 offset:1296
    ds_write_b16_d16_hi v92, v178 offset:1360
    ds_write_b16 v92, v147 offset:1440
    ds_write_b16 v92, v179 offset:1504
    ds_write_b16_d16_hi v92, v147 offset:1584
    ds_write_b16_d16_hi v92, v179 offset:1648
    ds_write_b16 v92, v148 offset:2304
    ds_write_b16 v92, v180 offset:2368
    ds_write_b16_d16_hi v92, v148 offset:2448
    ds_write_b16_d16_hi v92, v180 offset:2512
    ds_write_b16 v92, v149 offset:2592
    ds_write_b16 v92, v181 offset:2656
    ds_write_b16_d16_hi v92, v149 offset:2736
    ds_write_b16_d16_hi v92, v181 offset:2800
    v_lshrrev_b32 v93, 3, v0
    v_and_b32 v94, 7, v0
    v_mul_u32_u24 v92, 144, v93
    v_lshl_add_u32 v92, v94, 4, v92
    v_add_u32 v92, s37, v92
    v_lshlrev_b32 v93, 9, v93
    v_lshl_add_u32 v93, v94, 4, v93
    s_lshl_b32 s40, s8, 9
    s_lshl_b32 s41, s5, 7
    s_add_u32 s40, s40, s41
    s_waitcnt lgkmcnt(0)
    ds_read_b128 v[128:131], v92 offset:0
    ds_read_b128 v[132:135], v92 offset:1152
    ds_read_b128 v[136:139], v92 offset:2304
    s_sub_u32 s41, s9, 16
    s_lshl_b32 s41, s41, 3
    s_bfm_b64 s[42:43], s41, 0
    s_waitcnt lgkmcnt(0)
    buffer_store_dwordx4 v[128:131], v93, s[28:31], s40 offen sc1
    s_add_u32 s40, s40, 4096
    buffer_store_dwordx4 v[132:135], v93, s[28:31], s40 offen sc1
    s_add_u32 s40, s40, 4096
    s_mov_b64 exec, s[42:43]
    buffer_store_dwordx4 v[136:139], v93, s[28:31], s40 offen sc1
L_k2_fin:
L_k2_exit:
    s_endpgm
L_k2_slowlb:
    s_mov_b32 s47, 0
    v_mov_b32 v150, v144
    s_nop 1
    v_add_u32_dpp v150, v150, v150 row_shr:1 row_mask:0xf bank_mask:0xf bound_ctrl:0
    s_nop 1
    v_add_u32_dpp v150, v150, v150 row_shr:2 row_mask:0xf bank_mask:0xf bound_ctrl:0
    s_nop 1
    v_add_u32_dpp v150, v150, v150 row_shr:4 row_mask:0xf bank_mask:0xf bound_ctrl:0
    v_sub_u32 v151, v150, v144
    v_readlane_b32 s40, v150, 7
    v_readlane_b32 s41, v151, s6
    s_nop 3
    s_cmp_le_u32 s40, 3072
    s_cbranch_scc1 L_k2_r2
    v_cmp_le_u32 s[44:45], s32, v0
    v_sub_u32 v199, v193, v192
    s_nop 0
    v_cndmask_b32 v199, 0, v199, s[44:45]
    s_nop 1
    v_add_u32_dpp v199, v199, v199 row_shr:1 row_mask:0xf bank_mask:0xf bound_ctrl:0
    s_nop 1
    v_add_u32_dpp v199, v199, v199 row_shr:2 row_mask:0xf bank_mask:0xf bound_ctrl:0
    s_nop 1
    v_add_u32_dpp v199, v199, v199 row_shr:4 row_mask:0xf bank_mask:0xf bound_ctrl:0
    s_nop 1
    v_add_u32_dpp v199, v199, v199 row_shr:8 row_mask:0xf bank_mask:0xf bound_ctrl:0
    s_nop 1
    v_add_u32_dpp v199, v199, v199 row_bcast:15 row_mask:0xa bank_mask:0xf
    s_nop 1
    v_add_u32_dpp v199, v199, v199 row_bcast:31 row_mask:0xc bank_mask:0xf
    s_nop 1
    v_cmp_ge_u32 vcc, 3072, v199
    s_nop 3
    s_and_b64 s[44:45], s[44:45], vcc
    s_bcnt1_i32_b64 s40, s[44:45]
    s_add_u32 s33, s32, s40
    s_barrier
    s_branch L_k2_r1
L_k2_r2:
    v_add_u32 v197, s41, v197
    v_lshlrev_b32 v197, 1, v197
    v_add_u32 v197, 98816, v197
    s_lshl2_add_u32 s40, s6, 125440
    v_lshl_add_u32 v198, v0, 5, s40
    ds_write_b32 v198, v197
    s_branch L_k2_r3
L_k2_reload:
    s_lshl2_add_u32 s41, s48, 26214400
    buffer_load_dword v128, v208, s[24:27], s41 offen
    s_lshl2_add_u32 s41, s49, 26214400
    buffer_load_dword v129, v208, s[24:27], s41 offen
    s_lshl2_add_u32 s41, s50, 26214400
    buffer_load_dword v130, v208, s[24:27], s41 offen
    s_lshl2_add_u32 s41, s51, 26214400
    buffer_load_dword v131, v208, s[24:27], s41 offen
    s_lshl2_add_u32 s41, s52, 26214400
    buffer_load_dword v132, v208, s[24:27], s41 offen
    s_lshl2_add_u32 s41, s53, 26214400
    buffer_load_dword v133, v208, s[24:27], s41 offen
    s_lshl2_add_u32 s41, s54, 26214400
    buffer_load_dword v134, v208, s[24:27], s41 offen
    s_lshl2_add_u32 s41, s55, 26214400
    buffer_load_dword v135, v208, s[24:27], s41 offen
    s_branch L_k2_haverec
L_k2_mask:
    s_lshl_b32 s40, s6, 3
    s_cmp_ge_u32 s40, s32
    s_cselect_b32 s92, s56, 0
    s_cmp_lt_u32 s40, s33
    s_cselect_b32 s92, s92, 0
    s_add_u32 s40, s40, 1
    s_cmp_ge_u32 s40, s32
    s_cselect_b32 s93, s57, 0
    s_cmp_lt_u32 s40, s33
    s_cselect_b32 s93, s93, 0
    s_add_u32 s40, s40, 1
    s_cmp_ge_u32 s40, s32
    s_cselect_b32 s94, s58, 0
    s_cmp_lt_u32 s40, s33
    s_cselect_b32 s94, s94, 0
    s_add_u32 s40, s40, 1
    s_cmp_ge_u32 s40, s32
    s_cselect_b32 s95, s59, 0
    s_cmp_lt_u32 s40, s33
    s_cselect_b32 s95, s95, 0
    s_add_u32 s40, s40, 1
    s_cmp_ge_u32 s40, s32
    s_cselect_b32 s96, s60, 0
    s_cmp_lt_u32 s40, s33
    s_cselect_b32 s96, s96, 0
    s_add_u32 s40, s40, 1
    s_cmp_ge_u32 s40, s32
    s_cselect_b32 s97, s61, 0
    s_cmp_lt_u32 s40, s33
    s_cselect_b32 s97, s97, 0
    s_add_u32 s40, s40, 1
    s_cmp_ge_u32 s40, s32
    s_cselect_b32 s98, s62, 0
    s_cmp_lt_u32 s40, s33
    s_cselect_b32 s98, s98, 0
    s_add_u32 s40, s40, 1
    s_cmp_ge_u32 s40, s32
    s_cselect_b32 s99, s63, 0
    s_cmp_lt_u32 s40, s33
    s_cselect_b32 s99, s99, 0
    s_add_u32 s40, s40, 1
    s_branch L_k2_masked
L_k2_slowrows:
    s_movk_i32 s64, 64
    L_k2_sl_16:
    s_cmp_ge_u32 s64, s92
    s_cbranch_scc1 L_k2_sd_17
    s_add_u32 s65, s48, s64
    s_sub_u32 s66, s92, s64

    s_lshl2_add_u32 s41, s65, 26214400
    buffer_load_dword v128, v208, s[24:27], s41 offen
    s_waitcnt vmcnt(0)
    v_bfe_u32 v136, v128, 28, 3
    v_lshl_add_u32 v136, v136, 2, s47
    ds_read_b32 v136, v136 offset:0
    s_lshl_b32 s41, s64, 1
    s_waitcnt lgkmcnt(0)
    v_add_u32 v136, s41, v136
    v_cmpx_gt_u32 vcc, s66, v0
    v_add_u32 v136, v136, v203
    ds_write_b16 v136, v128
    ds_write_b16_d16_hi v136, v128 offset:6336
    v_lshl_add_u32 v136, v136, 1, s44
    v_add_u32 v92, s65, v0
    ds_write_b32 v136, v92
    s_mov_b64 exec, -1
    s_add_u32 s64, s64, 64
    s_branch L_k2_sl_16
    L_k2_sd_17:
    s_movk_i32 s64, 64
    L_k2_sl_18:
    s_cmp_ge_u32 s64, s93
    s_cbranch_scc1 L_k2_sd_19
    s_add_u32 s65, s49, s64
    s_sub_u32 s66, s93, s64

    s_lshl2_add_u32 s41, s65, 26214400
    buffer_load_dword v128, v208, s[24:27], s41 offen
    s_waitcnt vmcnt(0)
    v_bfe_u32 v136, v128, 28, 3
    v_lshl_add_u32 v136, v136, 2, s47
    ds_read_b32 v136, v136 offset:32
    s_lshl_b32 s41, s64, 1
    s_waitcnt lgkmcnt(0)
    v_add_u32 v136, s41, v136
    v_cmpx_gt_u32 vcc, s66, v0
    v_add_u32 v136, v136, v203
    ds_write_b16 v136, v128
    ds_write_b16_d16_hi v136, v128 offset:6336
    v_lshl_add_u32 v136, v136, 1, s44
    v_add_u32 v92, s65, v0
    ds_write_b32 v136, v92
    s_mov_b64 exec, -1
    s_add_u32 s64, s64, 64
    s_branch L_k2_sl_18
    L_k2_sd_19:
    s_movk_i32 s64, 64
    L_k2_sl_20:
    s_cmp_ge_u32 s64, s94
    s_cbranch_scc1 L_k2_sd_21
    s_add_u32 s65, s50, s64
    s_sub_u32 s66, s94, s64

    s_lshl2_add_u32 s41, s65, 26214400
    buffer_load_dword v128, v208, s[24:27], s41 offen
    s_waitcnt vmcnt(0)
    v_bfe_u32 v136, v128, 28, 3
    v_lshl_add_u32 v136, v136, 2, s47
    ds_read_b32 v136, v136 offset:64
    s_lshl_b32 s41, s64, 1
    s_waitcnt lgkmcnt(0)
    v_add_u32 v136, s41, v136
    v_cmpx_gt_u32 vcc, s66, v0
    v_add_u32 v136, v136, v203
    ds_write_b16 v136, v128
    ds_write_b16_d16_hi v136, v128 offset:6336
    v_lshl_add_u32 v136, v136, 1, s44
    v_add_u32 v92, s65, v0
    ds_write_b32 v136, v92
    s_mov_b64 exec, -1
    s_add_u32 s64, s64, 64
    s_branch L_k2_sl_20
    L_k2_sd_21:
    s_movk_i32 s64, 64
    L_k2_sl_22:
    s_cmp_ge_u32 s64, s95
    s_cbranch_scc1 L_k2_sd_23
    s_add_u32 s65, s51, s64
    s_sub_u32 s66, s95, s64

    s_lshl2_add_u32 s41, s65, 26214400
    buffer_load_dword v128, v208, s[24:27], s41 offen
    s_waitcnt vmcnt(0)
    v_bfe_u32 v136, v128, 28, 3
    v_lshl_add_u32 v136, v136, 2, s47
    ds_read_b32 v136, v136 offset:96
    s_lshl_b32 s41, s64, 1
    s_waitcnt lgkmcnt(0)
    v_add_u32 v136, s41, v136
    v_cmpx_gt_u32 vcc, s66, v0
    v_add_u32 v136, v136, v203
    ds_write_b16 v136, v128
    ds_write_b16_d16_hi v136, v128 offset:6336
    v_lshl_add_u32 v136, v136, 1, s44
    v_add_u32 v92, s65, v0
    ds_write_b32 v136, v92
    s_mov_b64 exec, -1
    s_add_u32 s64, s64, 64
    s_branch L_k2_sl_22
    L_k2_sd_23:
    s_movk_i32 s64, 64
    L_k2_sl_24:
    s_cmp_ge_u32 s64, s96
    s_cbranch_scc1 L_k2_sd_25
    s_add_u32 s65, s52, s64
    s_sub_u32 s66, s96, s64

    s_lshl2_add_u32 s41, s65, 26214400
    buffer_load_dword v128, v208, s[24:27], s41 offen
    s_waitcnt vmcnt(0)
    v_bfe_u32 v136, v128, 28, 3
    v_lshl_add_u32 v136, v136, 2, s47
    ds_read_b32 v136, v136 offset:128
    s_lshl_b32 s41, s64, 1
    s_waitcnt lgkmcnt(0)
    v_add_u32 v136, s41, v136
    v_cmpx_gt_u32 vcc, s66, v0
    v_add_u32 v136, v136, v203
    ds_write_b16 v136, v128
    ds_write_b16_d16_hi v136, v128 offset:6336
    v_lshl_add_u32 v136, v136, 1, s44
    v_add_u32 v92, s65, v0
    ds_write_b32 v136, v92
    s_mov_b64 exec, -1
    s_add_u32 s64, s64, 64
    s_branch L_k2_sl_24
    L_k2_sd_25:
    s_movk_i32 s64, 64
    L_k2_sl_26:
    s_cmp_ge_u32 s64, s97
    s_cbranch_scc1 L_k2_sd_27
    s_add_u32 s65, s53, s64
    s_sub_u32 s66, s97, s64

    s_lshl2_add_u32 s41, s65, 26214400
    buffer_load_dword v128, v208, s[24:27], s41 offen
    s_waitcnt vmcnt(0)
    v_bfe_u32 v136, v128, 28, 3
    v_lshl_add_u32 v136, v136, 2, s47
    ds_read_b32 v136, v136 offset:160
    s_lshl_b32 s41, s64, 1
    s_waitcnt lgkmcnt(0)
    v_add_u32 v136, s41, v136
    v_cmpx_gt_u32 vcc, s66, v0
    v_add_u32 v136, v136, v203
    ds_write_b16 v136, v128
    ds_write_b16_d16_hi v136, v128 offset:6336
    v_lshl_add_u32 v136, v136, 1, s44
    v_add_u32 v92, s65, v0
    ds_write_b32 v136, v92
    s_mov_b64 exec, -1
    s_add_u32 s64, s64, 64
    s_branch L_k2_sl_26
    L_k2_sd_27:
    s_movk_i32 s64, 64
    L_k2_sl_28:
    s_cmp_ge_u32 s64, s98
    s_cbranch_scc1 L_k2_sd_29
    s_add_u32 s65, s54, s64
    s_sub_u32 s66, s98, s64

    s_lshl2_add_u32 s41, s65, 26214400
    buffer_load_dword v128, v208, s[24:27], s41 offen
    s_waitcnt vmcnt(0)
    v_bfe_u32 v136, v128, 28, 3
    v_lshl_add_u32 v136, v136, 2, s47
    ds_read_b32 v136, v136 offset:192
    s_lshl_b32 s41, s64, 1
    s_waitcnt lgkmcnt(0)
    v_add_u32 v136, s41, v136
    v_cmpx_gt_u32 vcc, s66, v0
    v_add_u32 v136, v136, v203
    ds_write_b16 v136, v128
    ds_write_b16_d16_hi v136, v128 offset:6336
    v_lshl_add_u32 v136, v136, 1, s44
    v_add_u32 v92, s65, v0
    ds_write_b32 v136, v92
    s_mov_b64 exec, -1
    s_add_u32 s64, s64, 64
    s_branch L_k2_sl_28
    L_k2_sd_29:
    s_movk_i32 s64, 64
    L_k2_sl_30:
    s_cmp_ge_u32 s64, s99
    s_cbranch_scc1 L_k2_sd_31
    s_add_u32 s65, s55, s64
    s_sub_u32 s66, s99, s64

    s_lshl2_add_u32 s41, s65, 26214400
    buffer_load_dword v128, v208, s[24:27], s41 offen
    s_waitcnt vmcnt(0)
    v_bfe_u32 v136, v128, 28, 3
    v_lshl_add_u32 v136, v136, 2, s47
    ds_read_b32 v136, v136 offset:224
    s_lshl_b32 s41, s64, 1
    s_waitcnt lgkmcnt(0)
    v_add_u32 v136, s41, v136
    v_cmpx_gt_u32 vcc, s66, v0
    v_add_u32 v136, v136, v203
    ds_write_b16 v136, v128
    ds_write_b16_d16_hi v136, v128 offset:6336
    v_lshl_add_u32 v136, v136, 1, s44
    v_add_u32 v92, s65, v0
    ds_write_b32 v136, v92
    s_mov_b64 exec, -1
    s_add_u32 s64, s64, 64
    s_branch L_k2_sl_30
    L_k2_sd_31:
    s_branch L_k2_pl_done
L_k2_empty:
    s_cmp_eq_u32 s3, 0
    s_cbranch_scc1 L_k2_tiles_done
    s_mul_i32 s43, s6, 3072
    s_add_u32 s43, s43, 132736
    s_sub_u32 s43, s43, s37
    v_add_u32 v207, s43, v12
    v_xor_b32 v208, 32, v207
    v_xor_b32 v209, 64, v207
    v_xor_b32 v210, 96, v207
    s_waitcnt vmcnt(0)
    ds_read_b128 v[160:163], v12 offset:4096
    ds_read_b128 v[164:167], v13 offset:4096
    ds_read_b128 v[168:171], v14 offset:4096
    ds_read_b128 v[172:175], v15 offset:4096
    ds_read_b128 v[68:71], v207
    ds_read_b128 v[72:75], v208
    ds_read_b128 v[76:79], v209
    ds_read_b128 v[80:83], v210
    s_waitcnt lgkmcnt(0)
    s_waitcnt lgkmcnt(0)
    s_mov_b32 exec_lo, 0x000fffff
    s_mov_b32 exec_hi, 0x000fffff
    ds_write_b128 v206, v[68:71]
    ds_write_b128 v206, v[72:75] offset:32
    ds_write_b128 v206, v[76:79] offset:64
    ds_write_b128 v206, v[80:83] offset:96
    s_mov_b64 exec, -1
    v_mfma_f32_32x32x16_bf16 v[96:111], v[160:163], v[44:47], 0
    v_mfma_f32_32x32x16_bf16 v[112:127], v[168:171], v[44:47], 0
    v_mfma_f32_32x32x16_bf16 v[96:111], v[164:167], v[48:51], v[96:111]
    v_mfma_f32_32x32x16_bf16 v[112:127], v[172:175], v[48:51], v[112:127]
    s_mov_b32 s3, 0
    s_branch L_k2_tiles_done
L_k2_end:
.section .rodata,"a"
.p2align 6
.amdhsa_kernel egc_k1_kernel
  .amdhsa_next_free_vgpr 240
  .amdhsa_next_free_sgpr 96
  .amdhsa_accum_offset 240
  .amdhsa_group_segment_fixed_size 0
  .amdhsa_kernarg_size 80
  .amdhsa_user_sgpr_count 2
  .amdhsa_user_sgpr_kernarg_segment_ptr 1
  .amdhsa_system_sgpr_workgroup_id_x 1
  .amdhsa_float_denorm_mode_32 3
.end_amdhsa_kernel
.p2align 6
L_k2_kd:
.amdhsa_kernel egc_k2_kernel
  .amdhsa_next_free_vgpr 224
  .amdhsa_next_free_sgpr 102
  .amdhsa_accum_offset 224
  .amdhsa_group_segment_fixed_size 0
  .amdhsa_kernarg_size 80
  .amdhsa_user_sgpr_count 2
  .amdhsa_user_sgpr_kernarg_segment_ptr 1
  .amdhsa_system_sgpr_workgroup_id_x 1
  .amdhsa_float_denorm_mode_32 3
.end_amdhsa_kernel
```
